```python
import torch

def _softmax(x, axis=-1):
    return torch.softmax(x, dim=axis)
def _gelu(x):
    return torch.nn.functional.gelu(x, approximate="tanh")
def _silu(x):
    return torch.nn.functional.silu(x)
def _sigmoid(x):
    return torch.sigmoid(x)
def _layernorm(x, axis=-1, eps=1e-5):
    m = x.mean(dim=axis, keepdim=True)
    v = x.var(dim=axis, keepdim=True, unbiased=False)
    return (x - m) / torch.sqrt(v + eps)
def _scatter_add(tgt, idx, src, axis=0):
    return tgt.clone().index_add_(axis, idx, src)
def _segment_sum(src, seg, n):
    out = torch.zeros((n,) + src.shape[1:], dtype=src.dtype)
    return out.index_add_(0, seg, src)
def _pad(x, pw):
    flat = tuple(v for pair in reversed(pw) for v in pair)
    return torch.nn.functional.pad(x, flat)

kernel_name = 'concat_heads__gqa_block_cached__sliding_block_cached__decode'

def setup_inputs():

    _w = (lambda a: (lambda t: t.to(torch.bfloat16) if t.is_floating_point() else t)(torch.as_tensor(a)))
    def _A_setup():
        B, Sq, D = 2, 1, 448
        Hq, Hkv, Sk, Dh = 16, 8, 8192, 256
        assert Hq % Hkv == 0, (Hq, Hkv)
        return {
            "x": _w((lambda *s: torch.randn(*s, dtype=torch.bfloat16) * 0.8)(B, Sq, D)),
            "k_cache": _w((lambda *s: torch.randn(*s, dtype=torch.bfloat16) * 1.6)(B, Hkv, Sk, Dh)),
            "v_cache": _w((lambda *s: torch.randn(*s, dtype=torch.bfloat16) * 0.2)(B, Hkv, Sk, Dh)),
            "wq": _w((lambda *s: torch.randn(*s, dtype=torch.bfloat16) * 1.6)(D, Hq * Dh) * (D ** -0.5)),
            "wo": _w((lambda *s: torch.randn(*s, dtype=torch.bfloat16) * 0.2)(Hq * Dh, D) * ((Hq * Dh) ** -0.5)),
        }
    _A_in = _A_setup()

    def _B_setup():
        B, Sq, D = 2, 1, 448
        Hq, Hkv, Sk, Dh = 16, 8, 8192, 256
        assert Hq % Hkv == 0, (Hq, Hkv)
        return {
            "x": _w((lambda *s: torch.randn(*s, dtype=torch.bfloat16) * 0.8)(B, Sq, D)),
            "k_cache": _w((lambda *s: torch.randn(*s, dtype=torch.bfloat16) * 1.6)(B, Hkv, Sk, Dh)),
            "v_cache": _w((lambda *s: torch.randn(*s, dtype=torch.bfloat16) * 0.2)(B, Hkv, Sk, Dh)),
            "wq": _w((lambda *s: torch.randn(*s, dtype=torch.bfloat16) * 1.6)(D, Hq * Dh) * (D ** -0.5)),
            "wo": _w((lambda *s: torch.randn(*s, dtype=torch.bfloat16) * 0.2)(Hq * Dh, D) * ((Hq * Dh) ** -0.5)),
        }
    _B_in = _B_setup()

    return {
        "A_x": _A_in["x"],
        "A_k_cache": _A_in["k_cache"],
        "A_v_cache": _A_in["v_cache"],
        "A_wq": _A_in["wq"],
        "A_wo": _A_in["wo"],
        "B_x": _B_in["x"],
        "B_k_cache": _B_in["k_cache"],
        "B_v_cache": _B_in["v_cache"],
        "B_wq": _B_in["wq"],
        "B_wo": _B_in["wo"],
    }

def reference(A_x, A_k_cache, A_v_cache, A_wq, A_wo, B_x, B_k_cache, B_v_cache, B_wq, B_wo):
    def _A_ref(x, k_cache, v_cache, wq, wo):
        B, Sq, D = x.shape
        Hq, Dh = 16, 256
        Hkv = k_cache.shape[1]
        rep = Hq // Hkv
        q = (lambda x, *d: x.permute(*d))((x @ wq).reshape(B, Sq, Hq, Dh), 0, 2, 1, 3)
        k = (lambda x, n, axis: torch.repeat_interleave(x, n, dim=axis))(k_cache, rep, axis=1)
        v = (lambda x, n, axis: torch.repeat_interleave(x, n, dim=axis))(v_cache, rep, axis=1)
        scores = torch.einsum("bhqd,bhkd->bhqk", q, k) * (Dh ** -0.5)
        p = _softmax(scores, axis=-1)
        o = torch.einsum("bhqk,bhkd->bhqd", p, v)
        return (lambda x, *d: x.permute(*d))(o, 0, 2, 1, 3).reshape(B, Sq, Hq * Dh) @ wo

    def _B_ref(x, k_cache, v_cache, wq, wo):
        B, Sq, D = x.shape
        Hq, Dh = 16, 256
        Hkv, Sk = k_cache.shape[1], k_cache.shape[2]
        W = min(4096, max(256, Sk // 4))
        rep = Hq // Hkv
        q = (lambda x, *d: x.permute(*d))((x @ wq).reshape(B, Sq, Hq, Dh), 0, 2, 1, 3)
        k = (lambda x, n, axis: torch.repeat_interleave(x, n, dim=axis))(k_cache[:, :, Sk - W:, :], rep, axis=1)
        v = (lambda x, n, axis: torch.repeat_interleave(x, n, dim=axis))(v_cache[:, :, Sk - W:, :], rep, axis=1)
        scores = torch.einsum("bhqd,bhkd->bhqk", q, k) * (Dh ** -0.5)
        p = _softmax(scores, axis=-1)
        o = torch.einsum("bhqk,bhkd->bhqd", p, v)
        return (lambda x, *d: x.permute(*d))(o, 0, 2, 1, 3).reshape(B, Sq, Hq * Dh) @ wo

    a = _A_ref(A_x, A_k_cache, A_v_cache, A_wq, A_wo)
    b = _B_ref(B_x, B_k_cache, B_v_cache, B_wq, B_wo)
    return torch.concatenate([a, b], axis=-1)
```

```asm
; @launch grid=(256,1,1) block=(512,1,1) lds=40960
.amdgcn_target "amdgcn-amd-amdhsa--gfx950"
.text
.globl concat_heads__gqa_block_cached__sliding_block_cached__decode_kernel
.p2align 8
.type concat_heads__gqa_block_cached__sliding_block_cached__decode_kernel,@function
concat_heads__gqa_block_cached__sliding_block_cached__decode_kernel:
    s_cmp_ge_u32 s2, 256
    s_cbranch_scc1 L_end
    s_load_dwordx16 s[4:19], s[0:1], 0
    s_load_dwordx8 s[20:27], s[0:1], 64
    s_load_dwordx2 s[28:29], s[0:1], 96
    v_lshrrev_b32 v1, 6, v0
    s_lshr_b32 s70, s2, 7
    v_readfirstlane_b32 s3, v1
    v_and_b32 v0, 63, v0
    s_lshr_b32 s68, s2, 4
    s_and_b32 s68, s68, 7
    s_and_b32 s71, s2, 15
    s_add_u32 s79, s2, 5
    s_and_b32 s79, s79, 7
    s_lshl_b32 s79, s79, 1
    s_lshr_b32 s76, s71, 3
    s_or_b32 s79, s79, s76
    s_lshl_b32 s69, s70, 4
    s_add_u32 s69, s69, s71
    v_lshrrev_b32 v2, 2, v0
    v_and_b32 v3, 3, v0
    v_lshlrev_b32 v3, 4, v3
    v_lshl_add_u32 v4, v2, 15, v3
    v_lshlrev_b32 v5, 3, v2
    v_lshrrev_b32 v6, 4, v0
    v_and_b32 v7, 15, v0
    v_lshlrev_b32 v1, 4, v7
    v_lshl_add_u32 v1, v6, 11, v1
    s_lshl_b32 s76, s68, 10
    s_lshl_b32 s77, s79, 6
    s_add_u32 s76, s76, s77
    s_lshl_b32 s77, s3, 19
    s_add_u32 s30, s76, s77
    s_lshl_b32 s31, s3, 7
    s_mov_b32 s34, 67108864
    s_mov_b32 s35, 0x20000
    s_mov_b32 s38, 67108864
    s_mov_b32 s39, 0x20000
    s_mov_b32 s42, 67108864
    s_mov_b32 s43, 0x20000
    s_mov_b32 s46, 67108864
    s_mov_b32 s47, 0x20000
    s_mov_b32 s50, 3670016
    s_mov_b32 s51, 0x20000
    s_mov_b32 s54, 3670016
    s_mov_b32 s55, 0x20000
    s_mov_b32 s58, 1792
    s_mov_b32 s59, 0x20000
    s_mov_b32 s62, 283119104
    s_mov_b32 s63, 0x20000
    s_mov_b32 s66, 3584
    s_mov_b32 s67, 0x20000
    s_lshl_b32 s76, s70, 3
    s_add_u32 s76, s76, s68
    s_lshl_b32 s76, s76, 22
    s_lshl_b32 s77, s3, 13
    s_add_u32 s76, s76, s77
    s_lshl_b32 s77, s71, 16
    s_add_u32 s77, s76, s77
    s_add_u32 s77, s77, 3145728
    s_cmp_eq_u32 s70, 0
    s_waitcnt lgkmcnt(0)
    s_cselect_b64 s[56:57], s[4:5], s[14:15]
    s_cselect_b64 s[48:49], s[10:11], s[20:21]
    s_cselect_b64 s[52:53], s[12:13], s[22:23]
    s_mov_b64 s[40:41], s[16:17]
    s_mov_b64 s[32:33], s[6:7]
    s_mov_b64 s[36:37], s[8:9]
    s_mov_b32 s8, s77
    s_cmp_eq_u32 s3, 7
    s_cbranch_scc1 L_skipwq
    buffer_load_dwordx4 v[128:131], v4, s[48:51], s30 offen nt
    s_add_u32 s30, s30, 8192
    buffer_load_dwordx4 v[132:135], v4, s[48:51], s30 offen nt
    s_add_u32 s30, s30, 8192
    buffer_load_dwordx4 v[136:139], v4, s[48:51], s30 offen nt
    s_add_u32 s30, s30, 8192
    buffer_load_dwordx4 v[140:143], v4, s[48:51], s30 offen nt
    buffer_load_dwordx2 v[144:145], v5, s[56:59], s31 offen
    buffer_load_dwordx2 v[146:147], v5, s[56:59], s31 offen offset:896
L_skipwq:
    buffer_load_dwordx4 v[96:99], v1, s[40:43], s8 offen offset:0 nt
    buffer_load_dwordx4 v[100:103], v1, s[40:43], s8 offen offset:256 nt
    s_load_dword s72, s[28:29], 0
    s_mov_b64 s[44:45], s[18:19]
    s_mov_b64 s[60:61], s[28:29]
    s_mov_b64 s[64:65], s[24:25]
    s_lshl_b32 s77, s71, 18
    s_add_u32 s4, s76, s77
    s_add_u32 s5, s4, 65536
    s_add_u32 s6, s4, 131072
    s_add_u32 s7, s4, 196608
    s_mov_b32 s73, 0x05040100
    s_mov_b32 s74, 0x07060302
    s_mov_b32 s75, 0x3db8aa3b
    s_mov_b32 s10, 0x50005
    s_mov_b32 s11, 0x50005
    s_mov_b32 s12, 0xa000a
    s_mov_b32 s13, 0xa000a
    s_mov_b32 s14, 0x500050
    s_mov_b32 s15, 0x500050
    s_mov_b32 s16, 0xa000a0
    s_mov_b32 s17, 0xa000a0
    s_mov_b32 s18, 0x5000500
    s_mov_b32 s19, 0x5000500
    s_mov_b32 s20, 0xa000a00
    s_mov_b32 s21, 0xa000a00
    s_mov_b32 s22, 0x50005000
    s_mov_b32 s23, 0x50005000
    s_mov_b32 s24, 0xa000a000
    s_mov_b32 s25, 0xa000a000
    s_lshl_b32 s76, s68, 13
    s_add_u32 s76, s76, 4096
    s_lshl_b32 s77, s70, 12
    s_add_u32 s9, s76, s77
    s_lshl_b32 s77, s3, 9
    s_add_u32 s9, s9, s77
    v_and_b32 v5, 31, v0
    v_lshlrev_b32 v5, 4, v5
    v_mov_b32 v95, 4096
    s_mov_b32 m0, 0
    s_cmp_ge_u32 s3, 4
    s_cselect_b32 m0, 0x0, 0
    s_mov_b32 s77, 0xffffffff
    s_cselect_b32 s77, 0xffffffff, s77
    s_lshr_b32 s27, s79, 1
    s_cmp_eq_u32 s27, 3
    s_cselect_b32 m0, s77, m0
    s_cmp_eq_u32 s3, 7
    s_cbranch_scc1 L_svc
    s_barrier
    v_bfe_u32 v92, v0, 2, 1
    v_lshlrev_b32 v92, 7, v92
    v_lshl_add_u32 v92, v3, 1, v92
    v_bfe_u32 v93, v0, 3, 1
    v_lshl_add_u32 v92, v93, 4, v92
    v_bfe_u32 v93, v0, 4, 1
    v_lshl_add_u32 v92, v93, 3, v92
    v_bfe_u32 v93, v0, 5, 1
    v_lshl_add_u32 v92, v93, 2, v92
    s_lshl_b32 s76, s3, 8
    v_add_u32 v92, s76, v92
    s_waitcnt vmcnt(2)
    buffer_load_dwordx4 v[104:107], v1, s[40:43], s8 offen offset:512 nt
    v_perm_b32 v148, v132, v128, s73
    v_perm_b32 v149, v140, v136, s73
    v_perm_b32 v150, v132, v128, s74
    v_perm_b32 v151, v140, v136, s74
    v_perm_b32 v152, v133, v129, s73
    v_perm_b32 v153, v141, v137, s73
    v_perm_b32 v154, v133, v129, s74
    v_perm_b32 v155, v141, v137, s74
    v_perm_b32 v156, v134, v130, s73
    v_perm_b32 v157, v142, v138, s73
    v_perm_b32 v158, v134, v130, s74
    v_perm_b32 v159, v142, v138, s74
    v_perm_b32 v160, v135, v131, s73
    v_perm_b32 v161, v143, v139, s73
    v_perm_b32 v162, v135, v131, s74
    v_perm_b32 v163, v143, v139, s74
    v_dot2_f32_bf16 v164, v148, v144, 0
    v_dot2_f32_bf16 v165, v150, v144, 0
    v_dot2_f32_bf16 v166, v152, v144, 0
    v_dot2_f32_bf16 v167, v154, v144, 0
    v_dot2_f32_bf16 v168, v156, v144, 0
    v_dot2_f32_bf16 v169, v158, v144, 0
    v_dot2_f32_bf16 v170, v160, v144, 0
    v_dot2_f32_bf16 v171, v162, v144, 0
    v_dot2_f32_bf16 v172, v148, v146, 0
    v_dot2_f32_bf16 v173, v150, v146, 0
    v_dot2_f32_bf16 v174, v152, v146, 0
    v_dot2_f32_bf16 v175, v154, v146, 0
    v_dot2_f32_bf16 v176, v156, v146, 0
    v_dot2_f32_bf16 v177, v158, v146, 0
    v_dot2_f32_bf16 v178, v160, v146, 0
    v_dot2_f32_bf16 v179, v162, v146, 0
    v_dot2_f32_bf16 v164, v149, v145, v164
    v_dot2_f32_bf16 v165, v151, v145, v165
    v_dot2_f32_bf16 v166, v153, v145, v166
    v_dot2_f32_bf16 v167, v155, v145, v167
    v_dot2_f32_bf16 v168, v157, v145, v168
    v_dot2_f32_bf16 v169, v159, v145, v169
    v_dot2_f32_bf16 v170, v161, v145, v170
    v_dot2_f32_bf16 v171, v163, v145, v171
    v_dot2_f32_bf16 v172, v149, v147, v172
    v_dot2_f32_bf16 v173, v151, v147, v173
    v_dot2_f32_bf16 v174, v153, v147, v174
    v_dot2_f32_bf16 v175, v155, v147, v175
    v_dot2_f32_bf16 v176, v157, v147, v176
    v_dot2_f32_bf16 v177, v159, v147, v177
    v_dot2_f32_bf16 v178, v161, v147, v178
    v_dot2_f32_bf16 v179, v163, v147, v179
    s_nop 2
    v_add_f32_dpp v164, v164, v164 row_shl:4 row_mask:0xf bank_mask:0x5
    v_add_f32_dpp v165, v165, v165 row_shl:4 row_mask:0xf bank_mask:0x5
    v_add_f32_dpp v166, v166, v166 row_shl:4 row_mask:0xf bank_mask:0x5
    v_add_f32_dpp v167, v167, v167 row_shl:4 row_mask:0xf bank_mask:0x5
    v_add_f32_dpp v168, v168, v168 row_shl:4 row_mask:0xf bank_mask:0x5
    v_add_f32_dpp v169, v169, v169 row_shl:4 row_mask:0xf bank_mask:0x5
    v_add_f32_dpp v170, v170, v170 row_shl:4 row_mask:0xf bank_mask:0x5
    v_add_f32_dpp v171, v171, v171 row_shl:4 row_mask:0xf bank_mask:0x5
    v_add_f32_dpp v164, v172, v172 row_shr:4 row_mask:0xf bank_mask:0xa
    v_add_f32_dpp v165, v173, v173 row_shr:4 row_mask:0xf bank_mask:0xa
    v_add_f32_dpp v166, v174, v174 row_shr:4 row_mask:0xf bank_mask:0xa
    v_add_f32_dpp v167, v175, v175 row_shr:4 row_mask:0xf bank_mask:0xa
    v_add_f32_dpp v168, v176, v176 row_shr:4 row_mask:0xf bank_mask:0xa
    v_add_f32_dpp v169, v177, v177 row_shr:4 row_mask:0xf bank_mask:0xa
    v_add_f32_dpp v170, v178, v178 row_shr:4 row_mask:0xf bank_mask:0xa
    v_add_f32_dpp v171, v179, v179 row_shr:4 row_mask:0xf bank_mask:0xa
    s_nop 1
    v_add_f32_dpp v164, v164, v164 row_ror:8 row_mask:0xf bank_mask:0x3
    v_add_f32_dpp v165, v165, v165 row_ror:8 row_mask:0xf bank_mask:0x3
    v_add_f32_dpp v166, v166, v166 row_ror:8 row_mask:0xf bank_mask:0x3
    v_add_f32_dpp v167, v167, v167 row_ror:8 row_mask:0xf bank_mask:0x3
    v_add_f32_dpp v164, v168, v168 row_ror:8 row_mask:0xf bank_mask:0xc
    v_add_f32_dpp v165, v169, v169 row_ror:8 row_mask:0xf bank_mask:0xc
    v_add_f32_dpp v166, v170, v170 row_ror:8 row_mask:0xf bank_mask:0xc
    v_add_f32_dpp v167, v171, v171 row_ror:8 row_mask:0xf bank_mask:0xc
    s_nop 1
    v_permlane16_swap_b32 v164, v166
    v_permlane16_swap_b32 v165, v167
    s_nop 1
    v_add_f32 v164, v164, v166
    v_add_f32 v165, v165, v167
    s_nop 1
    v_permlane32_swap_b32 v164, v165
    s_nop 1
    v_add_f32 v164, v164, v165
    ds_write_b32 v92, v164 offset:0
    v_mov_b32 v93, 1
    s_mov_b64 exec, 1
    ds_add_u32 v95, v93
    s_mov_b64 exec, -1
    s_waitcnt lgkmcnt(0)
    s_mul_i32 s72, s72, 1664525
    s_add_u32 s72, s72, 1013904223
    s_branch L_main
L_svc:
    v_mov_b32 v128, 0
    v_mov_b32 v129, 0
    v_mov_b32 v130, 0
    v_mov_b32 v131, 0
    ds_write_b128 v95, v[128:131]
    ds_write_b128 v95, v[128:131] offset:16
    ds_write_b128 v95, v[128:131] offset:32
    s_waitcnt lgkmcnt(0)
    s_barrier
    buffer_load_dwordx4 v[104:107], v1, s[40:43], s8 offen offset:512 nt
    s_mul_i32 s72, s72, 1664525
    s_add_u32 s72, s72, 1013904223
    v_lshlrev_b32 v93, 4, v0
    v_lshrrev_b32 v94, 3, v0
    v_and_b32 v92, 7, v0
    v_lshlrev_b32 v92, 4, v92
    v_lshl_add_u32 v94, v94, 12, v92
    s_lshl_b32 s77, s70, 11
    s_add_u32 s30, s76, s77
    s_lshl_b32 s77, s79, 7
    s_add_u32 s30, s30, s77
    v_mov_b32 v162, s72
    v_mov_b32 v163, s72
    s_mov_b32 s78, 0
L_c1wait:
    ds_read_b32 v92, v95
    s_waitcnt lgkmcnt(0)
    v_readfirstlane_b32 s76, v92
    s_cmp_eq_u32 s76, 7
    s_cbranch_scc1 L_c1ok
    s_sleep 1
    s_add_u32 s78, s78, 1
    s_cmp_lt_u32 s78, 3200000
    s_cbranch_scc1 L_c1wait
    s_branch L_end
L_c1ok:
    ds_read_b128 v[128:131], v93 offset:0
    ds_read_b128 v[132:135], v93 offset:256
    ds_read_b128 v[136:139], v93 offset:512
    ds_read_b128 v[140:143], v93 offset:768
    ds_read_b128 v[144:147], v93 offset:1024
    ds_read_b128 v[148:151], v93 offset:1280
    ds_read_b128 v[152:155], v93 offset:1536
    s_waitcnt lgkmcnt(0)
    v_add_f32 v128, v128, v132
    v_add_f32 v129, v129, v133
    v_add_f32 v130, v130, v134
    v_add_f32 v131, v131, v135
    v_add_f32 v128, v128, v136
    v_add_f32 v129, v129, v137
    v_add_f32 v130, v130, v138
    v_add_f32 v131, v131, v139
    v_add_f32 v128, v128, v140
    v_add_f32 v129, v129, v141
    v_add_f32 v130, v130, v142
    v_add_f32 v131, v131, v143
    v_add_f32 v128, v128, v144
    v_add_f32 v129, v129, v145
    v_add_f32 v130, v130, v146
    v_add_f32 v131, v131, v147
    v_add_f32 v128, v128, v148
    v_add_f32 v129, v129, v149
    v_add_f32 v130, v130, v150
    v_add_f32 v131, v131, v151
    v_add_f32 v128, v128, v152
    v_add_f32 v129, v129, v153
    v_add_f32 v130, v130, v154
    v_add_f32 v131, v131, v155
    v_cvt_pk_bf16_f32 v160, v128, v129
    v_cvt_pk_bf16_f32 v161, v130, v131
    s_mov_b64 exec, 0xffff
    buffer_store_dwordx4 v[160:163], v94, s[60:63], s30 offen sc1
    s_mov_b64 exec, -1
    s_nop 0
L_main:
    s_bitcmp1_b32 m0, 3
    s_cbranch_scc1 L_sk3
    s_waitcnt vmcnt(2)
L_sk3:
    buffer_load_dwordx4 v[108:111], v1, s[40:43], s8 offen offset:768 nt
    s_waitcnt vmcnt(3)
    s_bitcmp1_b32 m0, 4
    s_cbranch_scc1 L_sk4
    s_waitcnt vmcnt(2)
L_sk4:
    buffer_load_dwordx4 v[112:115], v1, s[40:43], s8 offen offset:1024 nt
    s_waitcnt vmcnt(3)
    s_bitcmp1_b32 m0, 5
    s_cbranch_scc1 L_sk5
    s_waitcnt vmcnt(2)
L_sk5:
    buffer_load_dwordx4 v[116:119], v1, s[40:43], s8 offen offset:1280 nt
    s_waitcnt vmcnt(3)
    s_bitcmp1_b32 m0, 6
    s_cbranch_scc1 L_sk6
    s_waitcnt vmcnt(2)
L_sk6:
    buffer_load_dwordx4 v[120:123], v1, s[40:43], s8 offen offset:1536 nt
    s_waitcnt vmcnt(3)
    s_bitcmp1_b32 m0, 7
    s_cbranch_scc1 L_sk7
    s_waitcnt vmcnt(2)
L_sk7:
    buffer_load_dwordx4 v[124:127], v1, s[40:43], s8 offen offset:1792 nt
    s_waitcnt vmcnt(3)
    s_bitcmp1_b32 m0, 8
    s_cbranch_scc1 L_sk8
    s_waitcnt vmcnt(2)
L_sk8:
    buffer_load_dwordx4 v[128:131], v1, s[32:35], s4 offen offset:0 nt
    s_waitcnt vmcnt(3)
    s_bitcmp1_b32 m0, 9
    s_cbranch_scc1 L_sk9
    s_waitcnt vmcnt(2)
L_sk9:
    buffer_load_dwordx4 v[132:135], v1, s[32:35], s4 offen offset:256 nt
    s_waitcnt vmcnt(3)
    s_bitcmp1_b32 m0, 10
    s_cbranch_scc1 L_sk10
    s_waitcnt vmcnt(2)
L_sk10:
    buffer_load_dwordx4 v[136:139], v1, s[32:35], s4 offen offset:512 nt
    s_waitcnt vmcnt(3)
    s_bitcmp1_b32 m0, 11
    s_cbranch_scc1 L_sk11
    s_waitcnt vmcnt(2)
L_sk11:
    buffer_load_dwordx4 v[140:143], v1, s[32:35], s4 offen offset:768 nt
    s_waitcnt vmcnt(3)
    s_bitcmp1_b32 m0, 12
    s_cbranch_scc1 L_sk12
    s_waitcnt vmcnt(2)
L_sk12:
    buffer_load_dwordx4 v[144:147], v1, s[32:35], s4 offen offset:1024 nt
    s_waitcnt vmcnt(3)
    s_bitcmp1_b32 m0, 13
    s_cbranch_scc1 L_sk13
    s_waitcnt vmcnt(2)
L_sk13:
    buffer_load_dwordx4 v[148:151], v1, s[32:35], s4 offen offset:1280 nt
    s_waitcnt vmcnt(3)
    s_mov_b32 m0, 0
    s_bitcmp1_b32 m0, 14
    s_cbranch_scc1 L_sk14
    s_waitcnt vmcnt(2)
L_sk14:
    buffer_load_dwordx4 v[152:155], v1, s[32:35], s4 offen offset:1536 nt
    s_waitcnt vmcnt(3)
    s_bitcmp1_b32 m0, 15
    s_cbranch_scc1 L_sk15
    s_waitcnt vmcnt(2)
L_sk15:
    buffer_load_dwordx4 v[84:87], v5, s[60:63], s9 offen sc1
    s_waitcnt vmcnt(3)
    s_bitcmp1_b32 m0, 16
    s_cbranch_scc1 L_sk16
    s_waitcnt vmcnt(2)
L_sk16:
    buffer_load_dwordx4 v[156:159], v1, s[32:35], s4 offen offset:1792 nt
    s_waitcnt vmcnt(3)
    s_bitcmp1_b32 m0, 17
    s_cbranch_scc1 L_sk17
    s_waitcnt vmcnt(2)
L_sk17:
    buffer_load_dwordx4 v[160:163], v1, s[32:35], s5 offen offset:0 nt
    s_waitcnt vmcnt(3)
    s_bitcmp1_b32 m0, 18
    s_cbranch_scc1 L_sk18
    s_waitcnt vmcnt(2)
L_sk18:
    buffer_load_dwordx4 v[164:167], v1, s[32:35], s5 offen offset:256 nt
    s_waitcnt vmcnt(3)
    s_bitcmp1_b32 m0, 19
    s_cbranch_scc1 L_sk19
    s_waitcnt vmcnt(2)
L_sk19:
    buffer_load_dwordx4 v[168:171], v1, s[32:35], s5 offen offset:512 nt
    v_cmp_ne_u32 vcc, s72, v86
    s_cbranch_vccnz L_qslow
L_qok:
    v_lshrrev_b32 v92, 1, v5
    s_lshl_b32 s76, s3, 8
    v_add_u32 v92, s76, v92
    ds_write_b64 v92, v[84:85] offset:2048
    v_mov_b32 v93, 1
    v_mov_b32 v95, 4096
    s_mov_b64 exec, 1
    ds_add_u32 v95, v93 offset:4
    s_mov_b64 exec, -1
    s_waitcnt vmcnt(3)
    s_bitcmp1_b32 m0, 20
    s_cbranch_scc1 L_sk20
    s_waitcnt vmcnt(2)
L_sk20:
    buffer_load_dwordx4 v[172:175], v1, s[32:35], s5 offen offset:768 nt
    s_waitcnt vmcnt(3)
    s_bitcmp1_b32 m0, 21
    s_cbranch_scc1 L_sk21
    s_waitcnt vmcnt(2)
L_sk21:
    buffer_load_dwordx4 v[176:179], v1, s[32:35], s5 offen offset:1024 nt
    s_waitcnt vmcnt(3)
    s_bitcmp1_b32 m0, 22
    s_cbranch_scc1 L_sk22
    s_waitcnt vmcnt(2)
L_sk22:
    buffer_load_dwordx4 v[180:183], v1, s[32:35], s5 offen offset:1280 nt
    s_waitcnt vmcnt(3)
    s_bitcmp1_b32 m0, 23
    s_cbranch_scc1 L_sk23
    s_waitcnt vmcnt(2)
L_sk23:
    buffer_load_dwordx4 v[184:187], v1, s[32:35], s5 offen offset:1536 nt
    s_waitcnt vmcnt(3)
    s_bitcmp1_b32 m0, 24
    s_cbranch_scc1 L_sk24
    s_waitcnt vmcnt(2)
L_sk24:
    buffer_load_dwordx4 v[188:191], v1, s[32:35], s5 offen offset:1792 nt
    s_mov_b32 s78, 0
L_c2wait:
    ds_read_b32 v92, v95 offset:4
    s_waitcnt lgkmcnt(0)
    v_readfirstlane_b32 s76, v92
    s_cmp_eq_u32 s76, 8
    s_cbranch_scc1 L_c2ok
    s_sleep 1
    s_add_u32 s78, s78, 1
    s_cmp_lt_u32 s78, 3200000
    s_cbranch_scc1 L_c2wait
    s_branch L_end
L_c2ok:
    v_bfe_u32 v92, v0, 1, 1
    v_lshlrev_b32 v92, 9, v92
    v_lshl_add_u32 v92, v7, 4, v92
    v_xor_b32 v93, 512, v92
    ds_read_b128 v[8:11], v92 offset:3072
    ds_read_b128 v[16:19], v93 offset:3072
    ds_read_b128 v[12:15], v92 offset:3328
    ds_read_b128 v[20:23], v93 offset:3328
    ds_read_b128 v[24:27], v92 offset:2048
    ds_read_b128 v[32:35], v93 offset:2048
    ds_read_b128 v[28:31], v92 offset:2304
    ds_read_b128 v[36:39], v93 offset:2304
    v_mov_b32 v68, 0
    v_mov_b32 v69, 0
    v_mov_b32 v70, 0
    v_mov_b32 v71, 0
    v_mov_b32 v72, 0
    v_mov_b32 v73, 0
    v_mov_b32 v74, 0
    v_mov_b32 v75, 0
    v_mov_b32 v76, 0
    v_mov_b32 v77, 0
    v_mov_b32 v78, 0
    v_mov_b32 v79, 0
    v_mov_b32 v80, 0
    v_mov_b32 v81, 0
    v_mov_b32 v82, 0
    v_mov_b32 v83, 0
    s_waitcnt lgkmcnt(0)
    s_waitcnt vmcnt(3)
    s_bitcmp1_b32 m0, 25
    s_cbranch_scc1 L_sk25
    s_waitcnt vmcnt(2)
L_sk25:
    buffer_load_dwordx4 v[192:195], v1, s[32:35], s6 offen offset:0 nt
    v_dot2_f32_bf16 v60, v96, v8, 0
    v_dot2_f32_bf16 v64, v96, v16, 0
    v_dot2_f32_bf16 v61, v104, v8, 0
    v_dot2_f32_bf16 v65, v104, v16, 0
    v_dot2_f32_bf16 v62, v112, v8, 0
    v_dot2_f32_bf16 v66, v112, v16, 0
    v_dot2_f32_bf16 v63, v120, v8, 0
    v_dot2_f32_bf16 v67, v120, v16, 0
    v_dot2c_f32_bf16 v60, v97, v9
    v_dot2c_f32_bf16 v64, v97, v17
    v_dot2c_f32_bf16 v61, v105, v9
    v_dot2c_f32_bf16 v65, v105, v17
    v_dot2c_f32_bf16 v62, v113, v9
    v_dot2c_f32_bf16 v66, v113, v17
    v_dot2c_f32_bf16 v63, v121, v9
    v_dot2c_f32_bf16 v67, v121, v17
    s_waitcnt vmcnt(3)
    s_bitcmp1_b32 m0, 26
    s_cbranch_scc1 L_sk26
    s_waitcnt vmcnt(2)
L_sk26:
    buffer_load_dwordx4 v[196:199], v1, s[32:35], s6 offen offset:256 nt
    v_dot2c_f32_bf16 v60, v98, v10
    v_dot2c_f32_bf16 v64, v98, v18
    v_dot2c_f32_bf16 v61, v106, v10
    v_dot2c_f32_bf16 v65, v106, v18
    v_dot2c_f32_bf16 v62, v114, v10
    v_dot2c_f32_bf16 v66, v114, v18
    v_dot2c_f32_bf16 v63, v122, v10
    v_dot2c_f32_bf16 v67, v122, v18
    v_dot2c_f32_bf16 v60, v99, v11
    v_dot2c_f32_bf16 v64, v99, v19
    v_dot2c_f32_bf16 v61, v107, v11
    v_dot2c_f32_bf16 v65, v107, v19
    v_dot2c_f32_bf16 v62, v115, v11
    v_dot2c_f32_bf16 v66, v115, v19
    v_dot2c_f32_bf16 v63, v123, v11
    v_dot2c_f32_bf16 v67, v123, v19
    s_waitcnt vmcnt(3)
    s_bitcmp1_b32 m0, 27
    s_cbranch_scc1 L_sk27
    s_waitcnt vmcnt(2)
L_sk27:
    buffer_load_dwordx4 v[200:203], v1, s[32:35], s6 offen offset:512 nt
    v_dot2c_f32_bf16 v60, v100, v12
    v_dot2c_f32_bf16 v64, v100, v20
    v_dot2c_f32_bf16 v61, v108, v12
    v_dot2c_f32_bf16 v65, v108, v20
    v_dot2c_f32_bf16 v62, v116, v12
    v_dot2c_f32_bf16 v66, v116, v20
    v_dot2c_f32_bf16 v63, v124, v12
    v_dot2c_f32_bf16 v67, v124, v20
    v_dot2c_f32_bf16 v60, v101, v13
    v_dot2c_f32_bf16 v64, v101, v21
    v_dot2c_f32_bf16 v61, v109, v13
    v_dot2c_f32_bf16 v65, v109, v21
    v_dot2c_f32_bf16 v62, v117, v13
    v_dot2c_f32_bf16 v66, v117, v21
    v_dot2c_f32_bf16 v63, v125, v13
    v_dot2c_f32_bf16 v67, v125, v21
    s_waitcnt vmcnt(3)
    s_bitcmp1_b32 m0, 28
    s_cbranch_scc1 L_sk28
    s_waitcnt vmcnt(2)
L_sk28:
    buffer_load_dwordx4 v[204:207], v1, s[32:35], s6 offen offset:768 nt
    v_dot2c_f32_bf16 v60, v102, v14
    v_dot2c_f32_bf16 v64, v102, v22
    v_dot2c_f32_bf16 v61, v110, v14
    v_dot2c_f32_bf16 v65, v110, v22
    v_dot2c_f32_bf16 v62, v118, v14
    v_dot2c_f32_bf16 v66, v118, v22
    v_dot2c_f32_bf16 v63, v126, v14
    v_dot2c_f32_bf16 v67, v126, v22
    v_dot2c_f32_bf16 v60, v103, v15
    v_dot2c_f32_bf16 v64, v103, v23
    v_dot2c_f32_bf16 v61, v111, v15
    v_dot2c_f32_bf16 v65, v111, v23
    v_dot2c_f32_bf16 v62, v119, v15
    v_dot2c_f32_bf16 v66, v119, v23
    v_dot2c_f32_bf16 v63, v127, v15
    v_dot2c_f32_bf16 v67, v127, v23
    s_waitcnt vmcnt(3)
    s_bitcmp1_b32 m0, 29
    s_cbranch_scc1 L_sk29
    s_waitcnt vmcnt(2)
L_sk29:
    buffer_load_dwordx4 v[208:211], v1, s[32:35], s6 offen offset:1024 nt
    s_nop 2
    v_add_f32_dpp v40, v64, v60 quad_perm:[2,3,0,1] row_mask:0xf bank_mask:0xf
    v_add_f32_dpp v41, v65, v61 quad_perm:[2,3,0,1] row_mask:0xf bank_mask:0xf
    v_add_f32_dpp v42, v66, v62 quad_perm:[2,3,0,1] row_mask:0xf bank_mask:0xf
    v_add_f32_dpp v43, v67, v63 quad_perm:[2,3,0,1] row_mask:0xf bank_mask:0xf
    v_add_f32_dpp v40, v40, v40 quad_perm:[1,0,3,2] row_mask:0xf bank_mask:0xf
    v_add_f32_dpp v41, v41, v41 quad_perm:[1,0,3,2] row_mask:0xf bank_mask:0xf
    v_add_f32_dpp v42, v42, v42 quad_perm:[1,0,3,2] row_mask:0xf bank_mask:0xf
    v_add_f32_dpp v43, v43, v43 quad_perm:[1,0,3,2] row_mask:0xf bank_mask:0xf
    v_add_f32_dpp v40, v40, v40 row_ror:4 row_mask:0xf bank_mask:0xf
    v_add_f32_dpp v41, v41, v41 row_ror:4 row_mask:0xf bank_mask:0xf
    v_add_f32_dpp v42, v42, v42 row_ror:4 row_mask:0xf bank_mask:0xf
    v_add_f32_dpp v43, v43, v43 row_ror:4 row_mask:0xf bank_mask:0xf
    v_add_f32_dpp v40, v40, v40 row_ror:8 row_mask:0xf bank_mask:0xf
    v_add_f32_dpp v41, v41, v41 row_ror:8 row_mask:0xf bank_mask:0xf
    v_add_f32_dpp v42, v42, v42 row_ror:8 row_mask:0xf bank_mask:0xf
    s_waitcnt vmcnt(3)
    s_bitcmp1_b32 m0, 30
    s_cbranch_scc1 L_sk30
    s_waitcnt vmcnt(2)
L_sk30:
    buffer_load_dwordx4 v[212:215], v1, s[32:35], s6 offen offset:1280 nt
    v_add_f32_dpp v43, v43, v43 row_ror:8 row_mask:0xf bank_mask:0xf
    v_max3_f32 v92, v40, v41, v42
    v_max_f32 v92, v92, v43
    v_mov_b32 v93, v92
    s_nop 1
    v_permlane16_swap_b32 v92, v93
    s_nop 1
    v_max_f32 v92, v92, v93
    v_mov_b32 v93, v92
    s_nop 1
    v_permlane32_swap_b32 v92, v93
    s_nop 1
    v_max_f32 v92, v92, v93
    v_mul_f32 v92, s75, v92
    v_fma_f32 v40, v40, s75, -v92
    v_fma_f32 v41, v41, s75, -v92
    s_waitcnt vmcnt(3)
    s_bitcmp1_b32 m0, 31
    s_cbranch_scc1 L_sk31
    s_waitcnt vmcnt(2)
L_sk31:
    buffer_load_dwordx4 v[216:219], v1, s[32:35], s6 offen offset:1536 nt
    v_fma_f32 v42, v42, s75, -v92
    v_fma_f32 v43, v43, s75, -v92
    v_exp_f32 v40, v40
    v_exp_f32 v41, v41
    v_exp_f32 v42, v42
    v_exp_f32 v43, v43
    s_nop 0
    v_add_f32 v94, v40, v41
    v_add_f32 v94, v94, v42
    v_add_f32 v94, v94, v43
    v_mov_b32 v93, v94
    s_nop 1
    v_permlane16_swap_b32 v94, v93
    s_nop 1
    v_add_f32 v94, v94, v93
    v_mov_b32 v93, v94
    s_nop 1
    v_permlane32_swap_b32 v94, v93
    s_nop 1
    v_add_f32 v94, v94, v93
    v_cvt_pk_bf16_f32 v40, v40, v41
    v_cvt_pk_bf16_f32 v41, v42, v43
    v_mov_b32 v93, v94
    v_bfe_u32 v95, v0, 1, 1
    v_lshlrev_b32 v95, 6, v95
    s_lshl_b32 s76, s3, 3
    v_add_u32 v95, s76, v95
    ds_write_b64 v95, v[92:93] offset:4480
    v_mov_b32 v94, 1
    v_mov_b32 v95, 4096
    s_waitcnt vmcnt(3)
    s_bitcmp1_b32 m0, 0
    s_cbranch_scc1 L_sk32
    s_waitcnt vmcnt(2)
L_sk32:
    buffer_load_dwordx4 v[220:223], v1, s[32:35], s6 offen offset:1792 nt
    s_mov_b64 exec, 1
    ds_add_u32 v95, v94 offset:12
    s_mov_b64 exec, -1
    v_mul_u32_u24 v4, 7168, v6
    v_lshl_add_u32 v4, v7, 3, v4
    s_lshl_b32 s76, s68, 4
    s_add_u32 s76, s76, s79
    s_mul_i32 s76, s76, 28672
    s_min_u32 s77, s3, 6
    s_lshl_b32 s77, s77, 7
    s_add_u32 s30, s76, s77
    s_add_u32 s31, s30, 3584
    v_lshlrev_b32 v2, 5, v7
    v_lshl_add_u32 v2, v6, 3, v2
    s_lshl_b32 s76, s3, 11
    v_add_u32 v2, s76, v2
    v_dot2_f32_bf16 v60, v128, v24, 0
    v_dot2_f32_bf16 v64, v128, v32, 0
    v_dot2_f32_bf16 v61, v136, v24, 0
    v_dot2_f32_bf16 v65, v136, v32, 0
    v_dot2_f32_bf16 v62, v144, v24, 0
    v_dot2_f32_bf16 v66, v144, v32, 0
    v_dot2_f32_bf16 v63, v152, v24, 0
    v_dot2_f32_bf16 v67, v152, v32, 0
    v_dot2c_f32_bf16 v60, v129, v25
    v_dot2c_f32_bf16 v64, v129, v33
    v_dot2c_f32_bf16 v61, v137, v25
    v_dot2c_f32_bf16 v65, v137, v33
    v_dot2c_f32_bf16 v62, v145, v25
    v_dot2c_f32_bf16 v66, v145, v33
    v_dot2c_f32_bf16 v63, v153, v25
    v_dot2c_f32_bf16 v67, v153, v33
    s_waitcnt vmcnt(3)
    s_bitcmp1_b32 m0, 1
    s_cbranch_scc1 L_sk33
    s_waitcnt vmcnt(2)
L_sk33:
    buffer_load_dwordx4 v[224:227], v1, s[32:35], s7 offen offset:0 nt
    v_dot2c_f32_bf16 v60, v130, v26
    v_dot2c_f32_bf16 v64, v130, v34
    v_dot2c_f32_bf16 v61, v138, v26
    v_dot2c_f32_bf16 v65, v138, v34
    v_dot2c_f32_bf16 v62, v146, v26
    v_dot2c_f32_bf16 v66, v146, v34
    v_dot2c_f32_bf16 v63, v154, v26
    v_dot2c_f32_bf16 v67, v154, v34
    v_dot2c_f32_bf16 v60, v131, v27
    v_dot2c_f32_bf16 v64, v131, v35
    v_dot2c_f32_bf16 v61, v139, v27
    v_dot2c_f32_bf16 v65, v139, v35
    v_dot2c_f32_bf16 v62, v147, v27
    v_dot2c_f32_bf16 v66, v147, v35
    v_dot2c_f32_bf16 v63, v155, v27
    v_dot2c_f32_bf16 v67, v155, v35
    s_waitcnt vmcnt(3)
    s_bitcmp1_b32 m0, 2
    s_cbranch_scc1 L_sk34
    s_waitcnt vmcnt(2)
L_sk34:
    buffer_load_dwordx4 v[228:231], v1, s[32:35], s7 offen offset:256 nt
    v_dot2c_f32_bf16 v60, v132, v28
    v_dot2c_f32_bf16 v64, v132, v36
    v_dot2c_f32_bf16 v61, v140, v28
    v_dot2c_f32_bf16 v65, v140, v36
    v_dot2c_f32_bf16 v62, v148, v28
    v_dot2c_f32_bf16 v66, v148, v36
    v_dot2c_f32_bf16 v63, v156, v28
    v_dot2c_f32_bf16 v67, v156, v36
    v_dot2c_f32_bf16 v60, v133, v29
    v_dot2c_f32_bf16 v64, v133, v37
    v_dot2c_f32_bf16 v61, v141, v29
    v_dot2c_f32_bf16 v65, v141, v37
    v_dot2c_f32_bf16 v62, v149, v29
    v_dot2c_f32_bf16 v66, v149, v37
    v_dot2c_f32_bf16 v63, v157, v29
    v_dot2c_f32_bf16 v67, v157, v37
    s_waitcnt vmcnt(3)
    s_bitcmp1_b32 m0, 3
    s_cbranch_scc1 L_sk35
    s_waitcnt vmcnt(2)
L_sk35:
    buffer_load_dwordx4 v[232:235], v1, s[32:35], s7 offen offset:512 nt
    v_dot2c_f32_bf16 v60, v134, v30
    v_dot2c_f32_bf16 v64, v134, v38
    v_dot2c_f32_bf16 v61, v142, v30
    v_dot2c_f32_bf16 v65, v142, v38
    v_dot2c_f32_bf16 v62, v150, v30
    v_dot2c_f32_bf16 v66, v150, v38
    v_dot2c_f32_bf16 v63, v158, v30
    v_dot2c_f32_bf16 v67, v158, v38
    v_dot2c_f32_bf16 v60, v135, v31
    v_dot2c_f32_bf16 v64, v135, v39
    v_dot2c_f32_bf16 v61, v143, v31
    v_dot2c_f32_bf16 v65, v143, v39
    v_dot2c_f32_bf16 v62, v151, v31
    v_dot2c_f32_bf16 v66, v151, v39
    v_dot2c_f32_bf16 v63, v159, v31
    v_dot2c_f32_bf16 v67, v159, v39
    s_waitcnt vmcnt(3)
    s_bitcmp1_b32 m0, 4
    s_cbranch_scc1 L_sk36
    s_waitcnt vmcnt(2)
L_sk36:
    buffer_load_dwordx4 v[236:239], v1, s[32:35], s7 offen offset:768 nt
    s_nop 2
    v_add_f32_dpp v44, v64, v60 quad_perm:[2,3,0,1] row_mask:0xf bank_mask:0xf
    v_add_f32_dpp v45, v65, v61 quad_perm:[2,3,0,1] row_mask:0xf bank_mask:0xf
    v_add_f32_dpp v46, v66, v62 quad_perm:[2,3,0,1] row_mask:0xf bank_mask:0xf
    v_add_f32_dpp v47, v67, v63 quad_perm:[2,3,0,1] row_mask:0xf bank_mask:0xf
    v_add_f32_dpp v44, v44, v44 quad_perm:[1,0,3,2] row_mask:0xf bank_mask:0xf
    v_add_f32_dpp v45, v45, v45 quad_perm:[1,0,3,2] row_mask:0xf bank_mask:0xf
    v_add_f32_dpp v46, v46, v46 quad_perm:[1,0,3,2] row_mask:0xf bank_mask:0xf
    v_add_f32_dpp v47, v47, v47 quad_perm:[1,0,3,2] row_mask:0xf bank_mask:0xf
    v_add_f32_dpp v44, v44, v44 row_ror:4 row_mask:0xf bank_mask:0xf
    v_add_f32_dpp v45, v45, v45 row_ror:4 row_mask:0xf bank_mask:0xf
    v_add_f32_dpp v46, v46, v46 row_ror:4 row_mask:0xf bank_mask:0xf
    v_add_f32_dpp v47, v47, v47 row_ror:4 row_mask:0xf bank_mask:0xf
    v_add_f32_dpp v44, v44, v44 row_ror:8 row_mask:0xf bank_mask:0xf
    v_add_f32_dpp v45, v45, v45 row_ror:8 row_mask:0xf bank_mask:0xf
    v_add_f32_dpp v46, v46, v46 row_ror:8 row_mask:0xf bank_mask:0xf
    s_waitcnt vmcnt(3)
    s_bitcmp1_b32 m0, 5
    s_cbranch_scc1 L_sk37
    s_waitcnt vmcnt(2)
L_sk37:
    buffer_load_dwordx4 v[240:243], v1, s[32:35], s7 offen offset:1024 nt
    v_add_f32_dpp v47, v47, v47 row_ror:8 row_mask:0xf bank_mask:0xf
    v_dot2_f32_bf16 v60, v160, v24, 0
    v_dot2_f32_bf16 v64, v160, v32, 0
    v_dot2_f32_bf16 v61, v168, v24, 0
    v_dot2_f32_bf16 v65, v168, v32, 0
    v_dot2_f32_bf16 v62, v176, v24, 0
    v_dot2_f32_bf16 v66, v176, v32, 0
    v_dot2_f32_bf16 v63, v184, v24, 0
    v_dot2_f32_bf16 v67, v184, v32, 0
    v_dot2c_f32_bf16 v60, v161, v25
    v_dot2c_f32_bf16 v64, v161, v33
    v_dot2c_f32_bf16 v61, v169, v25
    v_dot2c_f32_bf16 v65, v169, v33
    v_dot2c_f32_bf16 v62, v177, v25
    v_dot2c_f32_bf16 v66, v177, v33
    v_dot2c_f32_bf16 v63, v185, v25
    s_waitcnt vmcnt(3)
    s_bitcmp1_b32 m0, 6
    s_cbranch_scc1 L_sk38
    s_waitcnt vmcnt(2)
L_sk38:
    buffer_load_dwordx4 v[244:247], v1, s[32:35], s7 offen offset:1280 nt
    v_dot2c_f32_bf16 v67, v185, v33
    v_dot2c_f32_bf16 v60, v162, v26
    v_dot2c_f32_bf16 v64, v162, v34
    v_dot2c_f32_bf16 v61, v170, v26
    v_dot2c_f32_bf16 v65, v170, v34
    v_dot2c_f32_bf16 v62, v178, v26
    v_dot2c_f32_bf16 v66, v178, v34
    v_dot2c_f32_bf16 v63, v186, v26
    v_dot2c_f32_bf16 v67, v186, v34
    v_dot2c_f32_bf16 v60, v163, v27
    v_dot2c_f32_bf16 v64, v163, v35
    v_dot2c_f32_bf16 v61, v171, v27
    v_dot2c_f32_bf16 v65, v171, v35
    v_dot2c_f32_bf16 v62, v179, v27
    v_dot2c_f32_bf16 v66, v179, v35
    v_dot2c_f32_bf16 v63, v187, v27
    s_waitcnt vmcnt(3)
    s_bitcmp1_b32 m0, 7
    s_cbranch_scc1 L_sk39
    s_waitcnt vmcnt(2)
L_sk39:
    buffer_load_dwordx4 v[248:251], v1, s[32:35], s7 offen offset:1536 nt
    v_dot2c_f32_bf16 v67, v187, v35
    v_dot2c_f32_bf16 v60, v164, v28
    v_dot2c_f32_bf16 v64, v164, v36
    v_dot2c_f32_bf16 v61, v172, v28
    v_dot2c_f32_bf16 v65, v172, v36
    v_dot2c_f32_bf16 v62, v180, v28
    v_dot2c_f32_bf16 v66, v180, v36
    v_dot2c_f32_bf16 v63, v188, v28
    v_dot2c_f32_bf16 v67, v188, v36
    v_dot2c_f32_bf16 v60, v165, v29
    v_dot2c_f32_bf16 v64, v165, v37
    v_dot2c_f32_bf16 v61, v173, v29
    v_dot2c_f32_bf16 v65, v173, v37
    v_dot2c_f32_bf16 v62, v181, v29
    v_dot2c_f32_bf16 v66, v181, v37
    v_dot2c_f32_bf16 v63, v189, v29
    s_waitcnt vmcnt(3)
    s_bitcmp1_b32 m0, 8
    s_cbranch_scc1 L_sk40
    s_waitcnt vmcnt(2)
L_sk40:
    buffer_load_dwordx4 v[252:255], v1, s[32:35], s7 offen offset:1792 nt
    v_dot2c_f32_bf16 v67, v189, v37
    v_dot2c_f32_bf16 v60, v166, v30
    v_dot2c_f32_bf16 v64, v166, v38
    v_dot2c_f32_bf16 v61, v174, v30
    v_dot2c_f32_bf16 v65, v174, v38
    v_dot2c_f32_bf16 v62, v182, v30
    v_dot2c_f32_bf16 v66, v182, v38
    v_dot2c_f32_bf16 v63, v190, v30
    v_dot2c_f32_bf16 v67, v190, v38
    v_dot2c_f32_bf16 v60, v167, v31
    v_dot2c_f32_bf16 v64, v167, v39
    v_dot2c_f32_bf16 v61, v175, v31
    v_dot2c_f32_bf16 v65, v175, v39
    v_dot2c_f32_bf16 v62, v183, v31
    v_dot2c_f32_bf16 v66, v183, v39
    v_dot2c_f32_bf16 v63, v191, v31
    s_waitcnt vmcnt(3)
    s_bitcmp1_b32 m0, 9
    s_cbranch_scc1 L_sk41
    s_waitcnt vmcnt(2)
L_sk41:
    buffer_load_dwordx4 v[96:99], v1, s[44:47], s8 offen offset:0 nt
    v_dot2c_f32_bf16 v67, v191, v39
    s_nop 2
    v_add_f32_dpp v48, v64, v60 quad_perm:[2,3,0,1] row_mask:0xf bank_mask:0xf
    v_add_f32_dpp v49, v65, v61 quad_perm:[2,3,0,1] row_mask:0xf bank_mask:0xf
    v_add_f32_dpp v50, v66, v62 quad_perm:[2,3,0,1] row_mask:0xf bank_mask:0xf
    v_add_f32_dpp v51, v67, v63 quad_perm:[2,3,0,1] row_mask:0xf bank_mask:0xf
    v_add_f32_dpp v48, v48, v48 quad_perm:[1,0,3,2] row_mask:0xf bank_mask:0xf
    v_add_f32_dpp v49, v49, v49 quad_perm:[1,0,3,2] row_mask:0xf bank_mask:0xf
    v_add_f32_dpp v50, v50, v50 quad_perm:[1,0,3,2] row_mask:0xf bank_mask:0xf
    v_add_f32_dpp v51, v51, v51 quad_perm:[1,0,3,2] row_mask:0xf bank_mask:0xf
    v_add_f32_dpp v48, v48, v48 row_ror:4 row_mask:0xf bank_mask:0xf
    v_add_f32_dpp v49, v49, v49 row_ror:4 row_mask:0xf bank_mask:0xf
    v_add_f32_dpp v50, v50, v50 row_ror:4 row_mask:0xf bank_mask:0xf
    v_add_f32_dpp v51, v51, v51 row_ror:4 row_mask:0xf bank_mask:0xf
    v_add_f32_dpp v48, v48, v48 row_ror:8 row_mask:0xf bank_mask:0xf
    v_add_f32_dpp v49, v49, v49 row_ror:8 row_mask:0xf bank_mask:0xf
    s_waitcnt vmcnt(3)
    s_bitcmp1_b32 m0, 10
    s_cbranch_scc1 L_sk42
    s_waitcnt vmcnt(2)
L_sk42:
    buffer_load_dwordx4 v[100:103], v1, s[44:47], s8 offen offset:256 nt
    v_add_f32_dpp v50, v50, v50 row_ror:8 row_mask:0xf bank_mask:0xf
    v_add_f32_dpp v51, v51, v51 row_ror:8 row_mask:0xf bank_mask:0xf
    v_dot2_f32_bf16 v60, v192, v24, 0
    v_dot2_f32_bf16 v64, v192, v32, 0
    v_dot2_f32_bf16 v61, v200, v24, 0
    v_dot2_f32_bf16 v65, v200, v32, 0
    v_dot2_f32_bf16 v62, v208, v24, 0
    v_dot2_f32_bf16 v66, v208, v32, 0
    v_dot2_f32_bf16 v63, v216, v24, 0
    v_dot2_f32_bf16 v67, v216, v32, 0
    v_dot2c_f32_bf16 v60, v193, v25
    v_dot2c_f32_bf16 v64, v193, v33
    v_dot2c_f32_bf16 v61, v201, v25
    v_dot2c_f32_bf16 v65, v201, v33
    v_dot2c_f32_bf16 v62, v209, v25
    v_dot2c_f32_bf16 v66, v209, v33
    s_waitcnt vmcnt(3)
    s_bitcmp1_b32 m0, 11
    s_cbranch_scc1 L_sk43
    s_waitcnt vmcnt(2)
L_sk43:
    buffer_load_dwordx4 v[104:107], v1, s[44:47], s8 offen offset:512 nt
    v_dot2c_f32_bf16 v63, v217, v25
    v_dot2c_f32_bf16 v67, v217, v33
    v_dot2c_f32_bf16 v60, v194, v26
    v_dot2c_f32_bf16 v64, v194, v34
    v_dot2c_f32_bf16 v61, v202, v26
    v_dot2c_f32_bf16 v65, v202, v34
    v_dot2c_f32_bf16 v62, v210, v26
    v_dot2c_f32_bf16 v66, v210, v34
    v_dot2c_f32_bf16 v63, v218, v26
    v_dot2c_f32_bf16 v67, v218, v34
    v_dot2c_f32_bf16 v60, v195, v27
    v_dot2c_f32_bf16 v64, v195, v35
    v_dot2c_f32_bf16 v61, v203, v27
    v_dot2c_f32_bf16 v65, v203, v35
    v_dot2c_f32_bf16 v62, v211, v27
    v_dot2c_f32_bf16 v66, v211, v35
    s_waitcnt vmcnt(3)
    s_bitcmp1_b32 m0, 12
    s_cbranch_scc1 L_sk44
    s_waitcnt vmcnt(2)
L_sk44:
    buffer_load_dwordx4 v[108:111], v1, s[44:47], s8 offen offset:768 nt
    v_dot2c_f32_bf16 v63, v219, v27
    v_dot2c_f32_bf16 v67, v219, v35
    v_dot2c_f32_bf16 v60, v196, v28
    v_dot2c_f32_bf16 v64, v196, v36
    v_dot2c_f32_bf16 v61, v204, v28
    v_dot2c_f32_bf16 v65, v204, v36
    v_dot2c_f32_bf16 v62, v212, v28
    v_dot2c_f32_bf16 v66, v212, v36
    v_dot2c_f32_bf16 v63, v220, v28
    v_dot2c_f32_bf16 v67, v220, v36
    v_dot2c_f32_bf16 v60, v197, v29
    v_dot2c_f32_bf16 v64, v197, v37
    v_dot2c_f32_bf16 v61, v205, v29
    v_dot2c_f32_bf16 v65, v205, v37
    v_dot2c_f32_bf16 v62, v213, v29
    v_dot2c_f32_bf16 v66, v213, v37
    s_waitcnt vmcnt(3)
    s_bitcmp1_b32 m0, 13
    s_cbranch_scc1 L_sk45
    s_waitcnt vmcnt(2)
L_sk45:
    buffer_load_dwordx4 v[112:115], v1, s[44:47], s8 offen offset:1024 nt
    v_dot2c_f32_bf16 v63, v221, v29
    v_dot2c_f32_bf16 v67, v221, v37
    v_dot2c_f32_bf16 v60, v198, v30
    v_dot2c_f32_bf16 v64, v198, v38
    v_dot2c_f32_bf16 v61, v206, v30
    v_dot2c_f32_bf16 v65, v206, v38
    v_dot2c_f32_bf16 v62, v214, v30
    v_dot2c_f32_bf16 v66, v214, v38
    v_dot2c_f32_bf16 v63, v222, v30
    v_dot2c_f32_bf16 v67, v222, v38
    v_dot2c_f32_bf16 v60, v199, v31
    v_dot2c_f32_bf16 v64, v199, v39
    v_dot2c_f32_bf16 v61, v207, v31
    v_dot2c_f32_bf16 v65, v207, v39
    v_dot2c_f32_bf16 v62, v215, v31
    v_dot2c_f32_bf16 v66, v215, v39
    s_waitcnt vmcnt(3)
    s_bitcmp1_b32 m0, 14
    s_cbranch_scc1 L_sk46
    s_waitcnt vmcnt(2)
L_sk46:
    buffer_load_dwordx4 v[116:119], v1, s[44:47], s8 offen offset:1280 nt
    v_dot2c_f32_bf16 v63, v223, v31
    v_dot2c_f32_bf16 v67, v223, v39
    s_nop 2
    v_add_f32_dpp v52, v64, v60 quad_perm:[2,3,0,1] row_mask:0xf bank_mask:0xf
    v_add_f32_dpp v53, v65, v61 quad_perm:[2,3,0,1] row_mask:0xf bank_mask:0xf
    v_add_f32_dpp v54, v66, v62 quad_perm:[2,3,0,1] row_mask:0xf bank_mask:0xf
    v_add_f32_dpp v55, v67, v63 quad_perm:[2,3,0,1] row_mask:0xf bank_mask:0xf
    v_add_f32_dpp v52, v52, v52 quad_perm:[1,0,3,2] row_mask:0xf bank_mask:0xf
    v_add_f32_dpp v53, v53, v53 quad_perm:[1,0,3,2] row_mask:0xf bank_mask:0xf
    v_add_f32_dpp v54, v54, v54 quad_perm:[1,0,3,2] row_mask:0xf bank_mask:0xf
    v_add_f32_dpp v55, v55, v55 quad_perm:[1,0,3,2] row_mask:0xf bank_mask:0xf
    v_add_f32_dpp v52, v52, v52 row_ror:4 row_mask:0xf bank_mask:0xf
    v_add_f32_dpp v53, v53, v53 row_ror:4 row_mask:0xf bank_mask:0xf
    v_add_f32_dpp v54, v54, v54 row_ror:4 row_mask:0xf bank_mask:0xf
    v_add_f32_dpp v55, v55, v55 row_ror:4 row_mask:0xf bank_mask:0xf
    v_add_f32_dpp v52, v52, v52 row_ror:8 row_mask:0xf bank_mask:0xf
    s_waitcnt vmcnt(3)
    s_bitcmp1_b32 m0, 15
    s_cbranch_scc1 L_sk47
    s_waitcnt vmcnt(2)
L_sk47:
    buffer_load_dwordx4 v[120:123], v1, s[44:47], s8 offen offset:1536 nt
    v_add_f32_dpp v53, v53, v53 row_ror:8 row_mask:0xf bank_mask:0xf
    v_add_f32_dpp v54, v54, v54 row_ror:8 row_mask:0xf bank_mask:0xf
    v_add_f32_dpp v55, v55, v55 row_ror:8 row_mask:0xf bank_mask:0xf
    v_dot2_f32_bf16 v60, v224, v24, 0
    v_dot2_f32_bf16 v64, v224, v32, 0
    v_dot2_f32_bf16 v61, v232, v24, 0
    v_dot2_f32_bf16 v65, v232, v32, 0
    v_dot2_f32_bf16 v62, v240, v24, 0
    v_dot2_f32_bf16 v66, v240, v32, 0
    v_dot2_f32_bf16 v63, v248, v24, 0
    v_dot2_f32_bf16 v67, v248, v32, 0
    v_dot2c_f32_bf16 v60, v225, v25
    v_dot2c_f32_bf16 v64, v225, v33
    v_dot2c_f32_bf16 v61, v233, v25
    v_dot2c_f32_bf16 v65, v233, v33
    v_dot2c_f32_bf16 v62, v241, v25
    s_lshl_b32 s9, s68, 1
    s_add_u32 s9, s9, s70
    s_lshl_b32 s9, s9, 11
    s_add_u32 s9, s9, 73728
    s_cmp_eq_u32 s3, 0
    s_cselect_b32 s78, 0x80000888, 0
    s_or_b32 m0, m0, s78
    s_bitcmp1_b32 m0, 16
    s_cbranch_scc1 L_sk48
    s_waitcnt vmcnt(2)
L_sk48:
    buffer_load_dwordx4 v[124:127], v1, s[44:47], s8 offen offset:1792 nt
    v_dot2c_f32_bf16 v66, v241, v33
    v_dot2c_f32_bf16 v63, v249, v25
    v_dot2c_f32_bf16 v67, v249, v33
    v_dot2c_f32_bf16 v60, v226, v26
    v_dot2c_f32_bf16 v64, v226, v34
    v_dot2c_f32_bf16 v61, v234, v26
    v_dot2c_f32_bf16 v65, v234, v34
    v_dot2c_f32_bf16 v62, v242, v26
    v_dot2c_f32_bf16 v66, v242, v34
    v_dot2c_f32_bf16 v63, v250, v26
    v_dot2c_f32_bf16 v67, v250, v34
    v_dot2c_f32_bf16 v60, v227, v27
    v_dot2c_f32_bf16 v64, v227, v35
    v_dot2c_f32_bf16 v61, v235, v27
    v_dot2c_f32_bf16 v65, v235, v35
    v_dot2c_f32_bf16 v62, v243, v27
    s_bitcmp1_b32 m0, 17
    s_cbranch_scc1 L_sk49
    s_waitcnt vmcnt(2)
L_sk49:
    buffer_load_dwordx4 v[128:131], v1, s[36:39], s4 offen offset:0 nt
    s_cmp_eq_u32 m0, -1
    s_cbranch_scc1 L_tg49
    s_cmp_lg_u32 s3, 0
    s_cbranch_scc1 L_to49
    s_branch L_tg49
L_to49:
    ds_read_b32 v3, v5 offset:4116
    s_waitcnt lgkmcnt(0)
    v_readfirstlane_b32 s78, v3
    s_or_b32 m0, m0, s78
L_tg49:
    v_dot2c_f32_bf16 v66, v243, v35
    v_dot2c_f32_bf16 v63, v251, v27
    v_dot2c_f32_bf16 v67, v251, v35
    v_dot2c_f32_bf16 v60, v228, v28
    v_dot2c_f32_bf16 v64, v228, v36
    v_dot2c_f32_bf16 v61, v236, v28
    v_dot2c_f32_bf16 v65, v236, v36
    v_dot2c_f32_bf16 v62, v244, v28
    v_dot2c_f32_bf16 v66, v244, v36
    v_dot2c_f32_bf16 v63, v252, v28
    v_dot2c_f32_bf16 v67, v252, v36
    v_dot2c_f32_bf16 v60, v229, v29
    v_dot2c_f32_bf16 v64, v229, v37
    v_dot2c_f32_bf16 v61, v237, v29
    v_dot2c_f32_bf16 v65, v237, v37
    v_dot2c_f32_bf16 v62, v245, v29
    s_bitcmp1_b32 m0, 18
    s_cbranch_scc1 L_sk50
    s_waitcnt vmcnt(2)
L_sk50:
    buffer_load_dwordx4 v[132:135], v1, s[36:39], s4 offen offset:256 nt
    v_dot2c_f32_bf16 v66, v245, v37
    v_dot2c_f32_bf16 v63, v253, v29
    v_dot2c_f32_bf16 v67, v253, v37
    v_dot2c_f32_bf16 v60, v230, v30
    v_dot2c_f32_bf16 v64, v230, v38
    v_dot2c_f32_bf16 v61, v238, v30
    v_dot2c_f32_bf16 v65, v238, v38
    v_dot2c_f32_bf16 v62, v246, v30
    v_dot2c_f32_bf16 v66, v246, v38
    v_dot2c_f32_bf16 v63, v254, v30
    v_dot2c_f32_bf16 v67, v254, v38
    v_dot2c_f32_bf16 v60, v231, v31
    v_dot2c_f32_bf16 v64, v231, v39
    v_dot2c_f32_bf16 v61, v239, v31
    v_dot2c_f32_bf16 v65, v239, v39
    v_dot2c_f32_bf16 v62, v247, v31
    s_bitcmp1_b32 m0, 19
    s_cbranch_scc1 L_sk51
    s_waitcnt vmcnt(2)
L_sk51:
    buffer_load_dwordx4 v[136:139], v1, s[36:39], s4 offen offset:512 nt
    s_cmp_eq_u32 m0, -1
    s_cbranch_scc1 L_tg51
    s_cmp_lg_u32 s3, 0
    s_cbranch_scc1 L_to51
    s_branch L_tg51
L_to51:
    ds_read_b32 v3, v5 offset:4116
    s_waitcnt lgkmcnt(0)
    v_readfirstlane_b32 s78, v3
    s_or_b32 m0, m0, s78
L_tg51:
    v_dot2c_f32_bf16 v66, v247, v39
    v_dot2c_f32_bf16 v63, v255, v31
    v_dot2c_f32_bf16 v67, v255, v39
    s_nop 2
    v_add_f32_dpp v56, v64, v60 quad_perm:[2,3,0,1] row_mask:0xf bank_mask:0xf
    v_add_f32_dpp v57, v65, v61 quad_perm:[2,3,0,1] row_mask:0xf bank_mask:0xf
    v_add_f32_dpp v58, v66, v62 quad_perm:[2,3,0,1] row_mask:0xf bank_mask:0xf
    v_add_f32_dpp v59, v67, v63 quad_perm:[2,3,0,1] row_mask:0xf bank_mask:0xf
    v_add_f32_dpp v56, v56, v56 quad_perm:[1,0,3,2] row_mask:0xf bank_mask:0xf
    v_add_f32_dpp v57, v57, v57 quad_perm:[1,0,3,2] row_mask:0xf bank_mask:0xf
    v_add_f32_dpp v58, v58, v58 quad_perm:[1,0,3,2] row_mask:0xf bank_mask:0xf
    v_add_f32_dpp v59, v59, v59 quad_perm:[1,0,3,2] row_mask:0xf bank_mask:0xf
    v_add_f32_dpp v56, v56, v56 row_ror:4 row_mask:0xf bank_mask:0xf
    v_add_f32_dpp v57, v57, v57 row_ror:4 row_mask:0xf bank_mask:0xf
    v_add_f32_dpp v58, v58, v58 row_ror:4 row_mask:0xf bank_mask:0xf
    v_add_f32_dpp v59, v59, v59 row_ror:4 row_mask:0xf bank_mask:0xf
    s_waitcnt vmcnt(7)
    s_bitcmp1_b32 m0, 20
    s_cbranch_scc1 L_sk52
    s_waitcnt vmcnt(2)
L_sk52:
    buffer_load_dwordx4 v[140:143], v1, s[36:39], s4 offen offset:768 nt
    v_add_f32_dpp v56, v56, v56 row_ror:8 row_mask:0xf bank_mask:0xf
    v_add_f32_dpp v57, v57, v57 row_ror:8 row_mask:0xf bank_mask:0xf
    v_add_f32_dpp v58, v58, v58 row_ror:8 row_mask:0xf bank_mask:0xf
    v_add_f32_dpp v59, v59, v59 row_ror:8 row_mask:0xf bank_mask:0xf
    v_max3_f32 v92, v44, v45, v46
    v_max3_f32 v92, v92, v47, v48
    v_max3_f32 v92, v92, v49, v50
    v_max3_f32 v92, v92, v51, v52
    v_max3_f32 v92, v92, v53, v54
    v_max3_f32 v92, v92, v55, v56
    v_max3_f32 v92, v92, v57, v58
    v_max_f32 v92, v92, v59
    v_mov_b32 v93, v92
    s_nop 1
    v_permlane16_swap_b32 v92, v93
    s_nop 1
    s_waitcnt vmcnt(7)
    s_bitcmp1_b32 m0, 21
    s_cbranch_scc1 L_sk53
    s_waitcnt vmcnt(2)
L_sk53:
    buffer_load_dwordx4 v[144:147], v1, s[36:39], s4 offen offset:1024 nt
    s_cmp_eq_u32 m0, -1
    s_cbranch_scc1 L_tg53
    s_cmp_lg_u32 s3, 0
    s_cbranch_scc1 L_to53
    s_branch L_tg53
L_to53:
    ds_read_b32 v3, v5 offset:4116
    s_waitcnt lgkmcnt(0)
    v_readfirstlane_b32 s78, v3
    s_or_b32 m0, m0, s78
L_tg53:
    v_max_f32 v92, v92, v93
    v_mov_b32 v93, v92
    s_nop 1
    v_permlane32_swap_b32 v92, v93
    s_nop 1
    v_max_f32 v92, v92, v93
    v_mul_f32 v92, s75, v92
    v_fma_f32 v44, v44, s75, -v92
    v_fma_f32 v45, v45, s75, -v92
    v_fma_f32 v46, v46, s75, -v92
    v_fma_f32 v47, v47, s75, -v92
    v_fma_f32 v48, v48, s75, -v92
    v_fma_f32 v49, v49, s75, -v92
    v_fma_f32 v50, v50, s75, -v92
    v_fma_f32 v51, v51, s75, -v92
    v_fma_f32 v52, v52, s75, -v92
    v_fma_f32 v53, v53, s75, -v92
    v_fma_f32 v54, v54, s75, -v92
    v_fma_f32 v55, v55, s75, -v92
    v_fma_f32 v56, v56, s75, -v92
    v_fma_f32 v57, v57, s75, -v92
    v_fma_f32 v58, v58, s75, -v92
    v_fma_f32 v59, v59, s75, -v92
    v_exp_f32 v44, v44
    v_exp_f32 v45, v45
    v_exp_f32 v46, v46
    v_exp_f32 v47, v47
    v_exp_f32 v48, v48
    v_exp_f32 v49, v49
    v_exp_f32 v50, v50
    v_exp_f32 v51, v51
    v_exp_f32 v52, v52
    v_exp_f32 v53, v53
    v_exp_f32 v54, v54
    v_exp_f32 v55, v55
    v_exp_f32 v56, v56
    v_exp_f32 v57, v57
    v_exp_f32 v58, v58
    v_exp_f32 v59, v59
    s_nop 0
    s_waitcnt vmcnt(7)
    s_bitcmp1_b32 m0, 22
    s_cbranch_scc1 L_sk54
    s_waitcnt vmcnt(2)
L_sk54:
    buffer_load_dwordx4 v[148:151], v1, s[36:39], s4 offen offset:1280 nt
    v_add_f32 v94, v44, v45
    v_add_f32 v94, v94, v46
    v_add_f32 v94, v94, v47
    v_add_f32 v94, v94, v48
    v_add_f32 v94, v94, v49
    v_add_f32 v94, v94, v50
    v_add_f32 v94, v94, v51
    v_add_f32 v94, v94, v52
    v_add_f32 v94, v94, v53
    v_add_f32 v94, v94, v54
    v_add_f32 v94, v94, v55
    v_add_f32 v94, v94, v56
    v_add_f32 v94, v94, v57
    v_add_f32 v94, v94, v58
    v_add_f32 v94, v94, v59
    v_mov_b32 v93, v94
    s_nop 1
    v_permlane16_swap_b32 v94, v93
    s_nop 1
    v_add_f32 v94, v94, v93
    v_mov_b32 v93, v94
    s_nop 1
    v_permlane32_swap_b32 v94, v93
    s_nop 1
    v_add_f32 v94, v94, v93
    v_cvt_pk_bf16_f32 v44, v44, v45
    v_cvt_pk_bf16_f32 v45, v46, v47
    v_cvt_pk_bf16_f32 v48, v48, v49
    v_cvt_pk_bf16_f32 v49, v50, v51
    v_cvt_pk_bf16_f32 v52, v52, v53
    v_cvt_pk_bf16_f32 v53, v54, v55
    v_cvt_pk_bf16_f32 v56, v56, v57
    v_cvt_pk_bf16_f32 v57, v58, v59
    v_mov_b32 v93, v94
    v_bfe_u32 v95, v0, 1, 1
    v_lshlrev_b32 v95, 6, v95
    s_lshl_b32 s76, s3, 3
    v_add_u32 v95, s76, v95
    ds_write_b64 v95, v[92:93] offset:4352
    v_mov_b32 v94, 1
    s_waitcnt vmcnt(7)
    s_bitcmp1_b32 m0, 23
    s_cbranch_scc1 L_sk55
    s_waitcnt vmcnt(2)
L_sk55:
    buffer_load_dwordx4 v[152:155], v1, s[36:39], s4 offen offset:1536 nt
    s_cmp_eq_u32 m0, -1
    s_cbranch_scc1 L_tg55
    s_cmp_lg_u32 s3, 0
    s_cbranch_scc1 L_to55
    s_branch L_tg55
L_to55:
    ds_read_b32 v3, v5 offset:4116
    s_waitcnt lgkmcnt(0)
    v_readfirstlane_b32 s78, v3
    s_or_b32 m0, m0, s78
L_tg55:
    v_mov_b32 v95, 4096
    s_mov_b64 exec, 1
    ds_add_u32 v95, v94 offset:8
    s_mov_b64 exec, -1
    s_mov_b32 s56, s72
    s_lshr_b32 s57, s72, 8
    s_lshr_b32 s58, s72, 16
    s_lshr_b32 s59, s72, 24
    v_mov_b32 v61, 0xff
    s_and_b32 s77, s3, 3
    s_lshl_b32 s76, s77, 9
    v_add_u32 v60, s76, v5
    v_and_b32 v66, 7, v7
    v_bfe_u32 v67, v0, 3, 2
    v_lshlrev_b32 v66, 4, v66
    v_lshl_add_u32 v62, v67, 12, v66
    v_lshrrev_b32 v67, 5, v0
    v_lshl_add_u32 v60, v67, 14, v60
    v_lshl_add_u32 v62, v67, 16, v62
    s_lshl_b32 s26, s68, 17
    s_add_u32 s26, s26, 196608
    s_lshl_b32 s76, s70, 4
    s_add_u32 s76, s76, s79
    s_lshl_b32 s76, s76, 12
    s_add_u32 s27, s26, s76
    s_lshl_b32 s76, s77, 14
    s_add_u32 s26, s26, s76
    s_lshl_b32 s76, s69, 7
    s_add_u32 s26, s26, s76
    v_lshlrev_b32 v63, 4, v6
    v_lshl_add_u32 v63, v7, 7, v63
    s_bfe_u32 s77, s3, 0x10001
    s_lshl_b32 s76, s77, 11
    s_add_u32 s27, s27, s76
    s_and_b32 s76, s3, 1
    s_lshl_b32 s76, s76, 6
    s_add_u32 s27, s27, s76
    s_lshl_b32 s29, s68, 1
    s_add_u32 s29, s29, s70
    s_lshl_b32 s29, s29, 1
    s_lshl_b32 s29, s68, 1
    s_add_u32 s29, s29, s77
    s_waitcnt vmcnt(7)
    s_bitcmp1_b32 m0, 24
    s_cbranch_scc1 L_sk56
    s_waitcnt vmcnt(2)
L_sk56:
    buffer_load_dwordx4 v[156:159], v1, s[36:39], s4 offen offset:1792 nt
    s_lshl_b32 s29, s29, 7
    s_lshr_b32 s76, s79, 3
    s_add_u32 s29, s29, s76
    s_lshl_b32 s29, s29, 4
    s_add_u32 s29, s29, 73728
    v_and_b32 v66, 1, v7
    v_lshlrev_b32 v66, 6, v66
    v_lshl_add_u32 v66, v6, 4, v66
    v_add_u32 v66, 4224, v66
    v_mov_b32 v67, 4128
    s_mov_b32 s76, 0x30003
    s_mov_b32 s77, 0x30003
    v_cndmask_b32 v42, v67, v66, s[76:77]
    s_mov_b32 s76, 0xc000c
    s_mov_b32 s77, 0xc000c
    v_cndmask_b32 v43, v67, v66, s[76:77]
    s_mov_b32 s76, 0x300030
    s_mov_b32 s77, 0x300030
    v_cndmask_b32 v46, v67, v66, s[76:77]
    s_mov_b32 s76, 0xc000c0
    s_mov_b32 s77, 0xc000c0
    v_cndmask_b32 v47, v67, v66, s[76:77]
    s_lshl_b32 s76, s3, 5
    v_lshlrev_b32 v64, 3, v6
    v_add_u32 v64, s76, v64
    v_and_b32 v66, 1, v7
    v_lshl_add_u32 v66, v66, 1, v6
    v_lshlrev_b32 v66, 4, v66
    v_lshrrev_b32 v67, 1, v7
    v_lshl_add_u32 v65, v67, 13, v66
    s_mul_i32 s28, s70, 458752
    s_lshl_b32 s76, s3, 16
    s_add_u32 s28, s28, s76
    s_lshr_b32 s76, s79, 1
    s_lshl_b32 s76, s76, 3
    s_add_u32 s76, s76, s68
    s_lshl_b32 s76, s76, 1
    s_and_b32 s77, s79, 1
    s_add_u32 s76, s76, s77
    s_mul_i32 s76, s76, 64
    s_waitcnt vmcnt(7)
    s_bitcmp1_b32 m0, 25
    s_cbranch_scc1 L_sk57
    s_waitcnt vmcnt(2)
L_sk57:
    buffer_load_dwordx4 v[160:163], v1, s[36:39], s5 offen offset:0 nt
    s_cmp_eq_u32 m0, -1
    s_cbranch_scc1 L_tg57
    s_cmp_lg_u32 s3, 0
    s_cbranch_scc1 L_to57
    s_branch L_tg57
L_to57:
    ds_read_b32 v3, v5 offset:4116
    s_waitcnt lgkmcnt(0)
    v_readfirstlane_b32 s78, v3
    s_or_b32 m0, m0, s78
L_tg57:
    s_add_u32 s28, s28, s76
    s_add_u32 s28, s28, 1245184
    v_lshlrev_b32 v66, 5, v7
    v_lshlrev_b32 v67, 4, v0
    v_lshlrev_b32 v92, 3, v7
    v_mov_b32 v95, 4096
    s_mov_b32 s78, 0
L_st1w:
    ds_read_b32 v94, v95 offset:12
    s_waitcnt lgkmcnt(0)
    v_readfirstlane_b32 s76, v94
    s_cmp_eq_u32 s76, 8
    s_cbranch_scc1 L_st1ok
    s_sleep 1
    s_add_u32 s78, s78, 1
    s_cmp_lt_u32 s78, 3200000
    s_cbranch_scc1 L_st1w
    s_branch L_end
L_st1ok:
    ds_read_b64 v[84:85], v92 offset:4480
    s_add_u32 s77, s3, 8
    v_mov_b32 v91, s72
    v_lshlrev_b32 v92, 5, v7
    s_lshl_b32 s76, s68, 7
    s_add_u32 s76, s76, s69
    s_lshl_b32 s76, s76, 3
    s_add_u32 s76, s76, 74240
    s_waitcnt lgkmcnt(0)
    v_max_f32_dpp v86, v84, v84 quad_perm:[1,0,3,2] row_mask:0xf bank_mask:0xf
    s_nop 1
    v_max_f32_dpp v86, v86, v86 quad_perm:[2,3,0,1] row_mask:0xf bank_mask:0xf
    s_nop 1
    v_max_f32_dpp v86, v86, v86 row_half_mirror row_mask:0xf bank_mask:0xf
    s_nop 1
    v_sub_f32 v84, v84, v86
    v_exp_f32 v84, v84
    s_nop 0
    v_mul_f32 v85, v85, v84
    s_nop 1
    v_add_f32_dpp v85, v85, v85 quad_perm:[1,0,3,2] row_mask:0xf bank_mask:0xf
    s_nop 1
    v_add_f32_dpp v85, v85, v85 quad_perm:[2,3,0,1] row_mask:0xf bank_mask:0xf
    s_nop 1
    v_add_f32_dpp v85, v85, v85 row_half_mirror row_mask:0xf bank_mask:0xf
    s_nop 1
    v_rcp_f32 v88, v85
    v_log_f32 v89, v85
    s_nop 0
    v_mul_f32 v84, v84, v88
    v_add_f32 v90, v86, v89
    v_readlane_b32 s50, v84, s3
    v_readlane_b32 s51, v84, s77
    v_mov_b32 v50, v90
    s_waitcnt vmcnt(7)
    s_bitcmp1_b32 m0, 26
    s_cbranch_scc1 L_sk58
    s_waitcnt vmcnt(2)
L_sk58:
    buffer_load_dwordx4 v[164:167], v1, s[36:39], s5 offen offset:256 nt
    v_cndmask_b32 v8, 0, v40, s[10:11]
    v_cndmask_b32 v9, 0, v41, s[10:11]
    v_cndmask_b32 v10, 0, v40, s[12:13]
    v_cndmask_b32 v11, 0, v41, s[12:13]
    v_cndmask_b32 v12, 0, v40, s[14:15]
    v_cndmask_b32 v13, 0, v41, s[14:15]
    v_cndmask_b32 v14, 0, v40, s[16:17]
    v_cndmask_b32 v15, 0, v41, s[16:17]
    v_cndmask_b32 v16, 0, v40, s[18:19]
    v_cndmask_b32 v17, 0, v41, s[18:19]
    v_cndmask_b32 v18, 0, v40, s[20:21]
    v_cndmask_b32 v19, 0, v41, s[20:21]
    v_cndmask_b32 v20, 0, v40, s[22:23]
    v_cndmask_b32 v21, 0, v41, s[22:23]
    v_cndmask_b32 v22, 0, v40, s[24:25]
    v_cndmask_b32 v23, 0, v41, s[24:25]
    v_perm_b32 v84, v104, v96, s73
    v_perm_b32 v85, v120, v112, s73
    v_perm_b32 v86, v108, v100, s73
    v_perm_b32 v87, v124, v116, s73
    v_mfma_f32_16x16x16_bf16 v[68:71], v[8:9], v[84:85], v[68:71]
    v_perm_b32 v88, v104, v96, s74
    v_perm_b32 v89, v120, v112, s74
    v_mfma_f32_16x16x16_bf16 v[72:75], v[8:9], v[86:87], v[72:75]
    v_perm_b32 v90, v108, v100, s74
    v_perm_b32 v91, v124, v116, s74
    v_mfma_f32_16x16x16_bf16 v[68:71], v[10:11], v[88:89], v[68:71]
    v_perm_b32 v84, v105, v97, s73
    v_perm_b32 v85, v121, v113, s73
    v_mfma_f32_16x16x16_bf16 v[72:75], v[10:11], v[90:91], v[72:75]
    v_perm_b32 v86, v109, v101, s73
    v_perm_b32 v87, v125, v117, s73
    v_mfma_f32_16x16x16_bf16 v[68:71], v[12:13], v[84:85], v[68:71]
    v_perm_b32 v88, v105, v97, s74
    v_perm_b32 v89, v121, v113, s74
    v_mfma_f32_16x16x16_bf16 v[72:75], v[12:13], v[86:87], v[72:75]
    v_perm_b32 v90, v109, v101, s74
    v_perm_b32 v91, v125, v117, s74
    v_mfma_f32_16x16x16_bf16 v[68:71], v[14:15], v[88:89], v[68:71]
    v_perm_b32 v84, v106, v98, s73
    s_waitcnt vmcnt(7)
    s_bitcmp1_b32 m0, 27
    s_cbranch_scc1 L_sk59
    s_waitcnt vmcnt(2)
L_sk59:
    buffer_load_dwordx4 v[168:171], v1, s[36:39], s5 offen offset:512 nt
    s_cmp_eq_u32 m0, -1
    s_cbranch_scc1 L_tg59
    s_cmp_lg_u32 s3, 0
    s_cbranch_scc1 L_to59
    s_branch L_tg59
L_to59:
    ds_read_b32 v3, v5 offset:4116
    s_waitcnt lgkmcnt(0)
    v_readfirstlane_b32 s78, v3
    s_or_b32 m0, m0, s78
L_tg59:
    v_perm_b32 v85, v122, v114, s73
    v_mfma_f32_16x16x16_bf16 v[72:75], v[14:15], v[90:91], v[72:75]
    v_perm_b32 v86, v110, v102, s73
    v_perm_b32 v87, v126, v118, s73
    v_mfma_f32_16x16x16_bf16 v[68:71], v[16:17], v[84:85], v[68:71]
    v_perm_b32 v88, v106, v98, s74
    v_perm_b32 v89, v122, v114, s74
    v_mfma_f32_16x16x16_bf16 v[72:75], v[16:17], v[86:87], v[72:75]
    v_perm_b32 v90, v110, v102, s74
    v_perm_b32 v91, v126, v118, s74
    v_mfma_f32_16x16x16_bf16 v[68:71], v[18:19], v[88:89], v[68:71]
    v_perm_b32 v84, v107, v99, s73
    v_perm_b32 v85, v123, v115, s73
    v_mfma_f32_16x16x16_bf16 v[72:75], v[18:19], v[90:91], v[72:75]
    v_perm_b32 v86, v111, v103, s73
    v_perm_b32 v87, v127, v119, s73
    v_mfma_f32_16x16x16_bf16 v[68:71], v[20:21], v[84:85], v[68:71]
    v_perm_b32 v88, v107, v99, s74
    v_perm_b32 v89, v123, v115, s74
    v_mfma_f32_16x16x16_bf16 v[72:75], v[20:21], v[86:87], v[72:75]
    v_perm_b32 v90, v111, v103, s74
    v_perm_b32 v91, v127, v119, s74
    v_mfma_f32_16x16x16_bf16 v[68:71], v[22:23], v[88:89], v[68:71]
    s_nop 1
    v_mfma_f32_16x16x16_bf16 v[72:75], v[22:23], v[90:91], v[72:75]
    s_nop 7
    s_waitcnt vmcnt(7)
    s_bitcmp1_b32 m0, 28
    s_cbranch_scc1 L_sk60
    s_waitcnt vmcnt(2)
L_sk60:
    buffer_load_dwordx4 v[172:175], v1, s[36:39], s5 offen offset:768 nt
    v_mul_f32 v68, s50, v68
    v_mul_f32 v69, s50, v69
    v_mul_f32 v70, s51, v70
    v_mul_f32 v71, s51, v71
    ds_write_b64 v2, v[68:69] offset:24576
    ds_write_b64 v2, v[70:71] offset:25600
    v_mul_f32 v72, s50, v72
    v_mul_f32 v73, s50, v73
    v_mul_f32 v74, s51, v74
    v_mul_f32 v75, s51, v75
    ds_write_b64 v2, v[72:73] offset:25088
    ds_write_b64 v2, v[74:75] offset:26112
    s_waitcnt vmcnt(7)
    s_bitcmp1_b32 m0, 29
    s_cbranch_scc1 L_sk61
    s_waitcnt vmcnt(2)
L_sk61:
    buffer_load_dwordx4 v[176:179], v1, s[36:39], s5 offen offset:1024 nt
    s_cmp_eq_u32 m0, -1
    s_cbranch_scc1 L_tg61
    s_cmp_lg_u32 s3, 0
    s_cbranch_scc1 L_to61
    s_branch L_tg61
L_to61:
    ds_read_b32 v3, v5 offset:4116
    s_waitcnt lgkmcnt(0)
    v_readfirstlane_b32 s78, v3
    s_or_b32 m0, m0, s78
L_tg61:
    s_waitcnt vmcnt(7)
    s_bitcmp1_b32 m0, 30
    s_cbranch_scc1 L_sk62
    s_waitcnt vmcnt(2)
L_sk62:
    s_cmp_lg_u32 s3, 0
    s_cbranch_scc1 L_sp62
    s_cmp_eq_u32 m0, -1
    s_cbranch_scc1 L_sp62
    buffer_load_dword v3, v5, s[60:63], s9 offen offset:8 sc1
L_sp62:
    buffer_load_dwordx4 v[180:183], v1, s[36:39], s5 offen offset:1280 nt
    s_waitcnt vmcnt(7)
    s_bitcmp1_b32 m0, 31
    s_cbranch_scc1 L_sk63
    s_waitcnt vmcnt(2)
L_sk63:
    buffer_load_dwordx4 v[184:187], v1, s[36:39], s5 offen offset:1536 nt
    s_cmp_eq_u32 m0, -1
    s_cbranch_scc1 L_tg63
    s_cmp_lg_u32 s3, 0
    s_cbranch_scc1 L_to63
    s_branch L_tg63
L_to63:
    ds_read_b32 v3, v5 offset:4116
    s_waitcnt lgkmcnt(0)
    v_readfirstlane_b32 s78, v3
    s_or_b32 m0, m0, s78
L_tg63:
    s_waitcnt vmcnt(7)
    s_bitcmp1_b32 m0, 0
    s_cbranch_scc1 L_sk64
    s_waitcnt vmcnt(2)
L_sk64:
    buffer_load_dwordx4 v[188:191], v1, s[36:39], s5 offen offset:1792 nt
    s_waitcnt vmcnt(7)
    s_bitcmp1_b32 m0, 1
    s_cbranch_scc1 L_sk65
    s_waitcnt vmcnt(2)
L_sk65:
    buffer_load_dwordx4 v[192:195], v1, s[36:39], s6 offen offset:0 nt
    s_cmp_eq_u32 m0, -1
    s_cbranch_scc1 L_tg65
    s_cmp_lg_u32 s3, 0
    s_cbranch_scc1 L_to65
    s_waitcnt vmcnt(4)
    v_cmp_eq_u32 vcc, s72, v3
    s_bcnt1_i32_b32 s78, vcc_lo
    s_cmp_lt_u32 s78, 2
    s_cbranch_scc1 L_tg65
    s_mov_b32 m0, -1
    v_mov_b32 v3, -1
    s_mov_b64 exec, 1
    ds_write_b32 v5, v3 offset:4116
    s_mov_b64 exec, -1
    s_branch L_tg65
L_to65:
    ds_read_b32 v3, v5 offset:4116
    s_waitcnt lgkmcnt(0)
    v_readfirstlane_b32 s78, v3
    s_or_b32 m0, m0, s78
L_tg65:
    s_waitcnt vmcnt(7)
    s_bitcmp1_b32 m0, 2
    s_cbranch_scc1 L_sk66
    s_waitcnt vmcnt(2)
L_sk66:
    s_cmp_lg_u32 s3, 0
    s_cbranch_scc1 L_sp66
    s_cmp_eq_u32 m0, -1
    s_cbranch_scc1 L_sp66
    buffer_load_dword v3, v5, s[60:63], s9 offen offset:8 sc1
L_sp66:
    buffer_load_dwordx4 v[196:199], v1, s[36:39], s6 offen offset:256 nt
    s_waitcnt vmcnt(7)
    s_bitcmp1_b32 m0, 3
    s_cbranch_scc1 L_sk67
    s_waitcnt vmcnt(2)
L_sk67:
    buffer_load_dwordx4 v[200:203], v1, s[36:39], s6 offen offset:512 nt
    s_cmp_eq_u32 m0, -1
    s_cbranch_scc1 L_tg67
    s_cmp_lg_u32 s3, 0
    s_cbranch_scc1 L_to67
    s_branch L_tg67
L_to67:
    ds_read_b32 v3, v5 offset:4116
    s_waitcnt lgkmcnt(0)
    v_readfirstlane_b32 s78, v3
    s_or_b32 m0, m0, s78
L_tg67:
    s_waitcnt vmcnt(7)
    s_bitcmp1_b32 m0, 4
    s_cbranch_scc1 L_sk68
    s_waitcnt vmcnt(2)
L_sk68:
    buffer_load_dwordx4 v[204:207], v1, s[36:39], s6 offen offset:768 nt
    s_waitcnt vmcnt(7)
    s_bitcmp1_b32 m0, 5
    s_cbranch_scc1 L_sk69
    s_waitcnt vmcnt(2)
L_sk69:
    buffer_load_dwordx4 v[208:211], v1, s[36:39], s6 offen offset:1024 nt
    s_cmp_eq_u32 m0, -1
    s_cbranch_scc1 L_tg69
    s_cmp_lg_u32 s3, 0
    s_cbranch_scc1 L_to69
    s_waitcnt vmcnt(4)
    v_cmp_eq_u32 vcc, s72, v3
    s_bcnt1_i32_b32 s78, vcc_lo
    s_cmp_lt_u32 s78, 2
    s_cbranch_scc1 L_tg69
    s_mov_b32 m0, -1
    v_mov_b32 v3, -1
    s_mov_b64 exec, 1
    ds_write_b32 v5, v3 offset:4116
    s_mov_b64 exec, -1
    s_branch L_tg69
L_to69:
    ds_read_b32 v3, v5 offset:4116
    s_waitcnt lgkmcnt(0)
    v_readfirstlane_b32 s78, v3
    s_or_b32 m0, m0, s78
L_tg69:
    s_waitcnt vmcnt(7)
    s_bitcmp1_b32 m0, 6
    s_cbranch_scc1 L_sk70
    s_waitcnt vmcnt(2)
L_sk70:
    s_cmp_lg_u32 s3, 0
    s_cbranch_scc1 L_sp70
    s_cmp_eq_u32 m0, -1
    s_cbranch_scc1 L_sp70
    buffer_load_dword v3, v5, s[60:63], s9 offen offset:8 sc1
L_sp70:
    buffer_load_dwordx4 v[212:215], v1, s[36:39], s6 offen offset:1280 nt
    s_waitcnt vmcnt(7)
    s_bitcmp1_b32 m0, 7
    s_cbranch_scc1 L_sk71
    s_waitcnt vmcnt(2)
L_sk71:
    buffer_load_dwordx4 v[216:219], v1, s[36:39], s6 offen offset:1536 nt
    s_cmp_eq_u32 m0, -1
    s_cbranch_scc1 L_tg71
    s_cmp_lg_u32 s3, 0
    s_cbranch_scc1 L_to71
    s_branch L_tg71
L_to71:
    ds_read_b32 v3, v5 offset:4116
    s_waitcnt lgkmcnt(0)
    v_readfirstlane_b32 s78, v3
    s_or_b32 m0, m0, s78
L_tg71:
    s_waitcnt vmcnt(7)
    s_bitcmp1_b32 m0, 8
    s_cbranch_scc1 L_sk72
    s_waitcnt vmcnt(2)
L_sk72:
    buffer_load_dwordx4 v[220:223], v1, s[36:39], s6 offen offset:1792 nt
    s_waitcnt vmcnt(7)
    s_bitcmp1_b32 m0, 9
    s_cbranch_scc1 L_sk73
    s_waitcnt vmcnt(2)
L_sk73:
    buffer_load_dwordx4 v[224:227], v1, s[36:39], s7 offen offset:0 nt
    s_cmp_eq_u32 m0, -1
    s_cbranch_scc1 L_tg73
    s_cmp_lg_u32 s3, 0
    s_cbranch_scc1 L_to73
    s_waitcnt vmcnt(4)
    v_cmp_eq_u32 vcc, s72, v3
    s_bcnt1_i32_b32 s78, vcc_lo
    s_cmp_lt_u32 s78, 2
    s_cbranch_scc1 L_tg73
    s_mov_b32 m0, -1
    v_mov_b32 v3, -1
    s_mov_b64 exec, 1
    ds_write_b32 v5, v3 offset:4116
    s_mov_b64 exec, -1
    s_branch L_tg73
L_to73:
    ds_read_b32 v3, v5 offset:4116
    s_waitcnt lgkmcnt(0)
    v_readfirstlane_b32 s78, v3
    s_or_b32 m0, m0, s78
L_tg73:
    s_waitcnt vmcnt(7)
    s_bitcmp1_b32 m0, 10
    s_cbranch_scc1 L_sk74
    s_waitcnt vmcnt(2)
L_sk74:
    s_cmp_lg_u32 s3, 0
    s_cbranch_scc1 L_sp74
    s_cmp_eq_u32 m0, -1
    s_cbranch_scc1 L_sp74
    buffer_load_dword v3, v5, s[60:63], s9 offen offset:8 sc1
L_sp74:
    buffer_load_dwordx4 v[232:235], v1, s[36:39], s7 offen offset:512 nt
    s_waitcnt vmcnt(7)
    s_bitcmp1_b32 m0, 11
    s_cbranch_scc1 L_sk75
    s_waitcnt vmcnt(2)
L_sk75:
    buffer_load_dwordx4 v[240:243], v1, s[36:39], s7 offen offset:1024 nt
    s_cmp_eq_u32 m0, -1
    s_cbranch_scc1 L_tg75
    s_cmp_lg_u32 s3, 0
    s_cbranch_scc1 L_to75
    s_branch L_tg75
L_to75:
    ds_read_b32 v3, v5 offset:4116
    s_waitcnt lgkmcnt(0)
    v_readfirstlane_b32 s78, v3
    s_or_b32 m0, m0, s78
L_tg75:
    v_lshlrev_b32 v92, 3, v7
    v_mov_b32 v95, 4096
    s_mov_b32 s78, 0
L_st0w:
    ds_read_b32 v94, v95 offset:8
    s_waitcnt lgkmcnt(0)
    v_readfirstlane_b32 s76, v94
    s_cmp_eq_u32 s76, 8
    s_cbranch_scc1 L_st0ok
    s_sleep 1
    s_add_u32 s78, s78, 1
    s_cmp_lt_u32 s78, 3200000
    s_cbranch_scc1 L_st0w
    s_branch L_end
L_st0ok:
    ds_read_b64 v[84:85], v92 offset:4352
    s_add_u32 s77, s3, 8
    v_mov_b32 v91, s72
    v_lshlrev_b32 v92, 5, v7
    s_lshl_b32 s76, s68, 7
    s_add_u32 s76, s76, s69
    s_lshl_b32 s76, s76, 3
    s_add_u32 s76, s76, 73728
    s_waitcnt lgkmcnt(0)
    v_max_f32_dpp v86, v84, v84 quad_perm:[1,0,3,2] row_mask:0xf bank_mask:0xf
    s_nop 1
    v_max_f32_dpp v86, v86, v86 quad_perm:[2,3,0,1] row_mask:0xf bank_mask:0xf
    s_nop 1
    v_max_f32_dpp v86, v86, v86 row_half_mirror row_mask:0xf bank_mask:0xf
    s_nop 1
    v_sub_f32 v84, v84, v86
    v_exp_f32 v84, v84
    s_nop 0
    v_mul_f32 v85, v85, v84
    s_nop 1
    v_add_f32_dpp v85, v85, v85 quad_perm:[1,0,3,2] row_mask:0xf bank_mask:0xf
    s_nop 1
    v_add_f32_dpp v85, v85, v85 quad_perm:[2,3,0,1] row_mask:0xf bank_mask:0xf
    s_nop 1
    v_add_f32_dpp v85, v85, v85 row_half_mirror row_mask:0xf bank_mask:0xf
    s_nop 1
    v_rcp_f32 v88, v85
    v_log_f32 v89, v85
    s_nop 0
    v_mul_f32 v84, v84, v88
    v_add_f32 v90, v86, v89
    v_readlane_b32 s48, v84, s3
    v_readlane_b32 s49, v84, s77
    v_mov_b32 v88, v90
    v_mov_b32 v89, v50
    v_mov_b32 v90, v91
    v_lshlrev_b32 v92, 1, v7
    s_lshl_b32 s76, s68, 1
    s_add_u32 s76, s76, s70
    s_lshl_b32 s76, s76, 6
    s_add_u32 s76, s76, s71
    s_lshl_b32 s76, s76, 5
    s_add_u32 s76, s76, 73728
    s_cmp_lg_u32 s3, 4
    s_cbranch_scc1 L_nopub0
    s_mov_b64 exec, 0x101
    buffer_store_dwordx4 v[88:91], v92, s[60:63], s76 offen sc1
    s_mov_b64 exec, -1
L_nopub0:
    s_nop 1
L_not1b:
    v_cndmask_b32 v8, 0, v44, s[10:11]
    v_cndmask_b32 v9, 0, v45, s[10:11]
    v_cndmask_b32 v10, 0, v44, s[12:13]
    v_cndmask_b32 v11, 0, v45, s[12:13]
    v_cndmask_b32 v12, 0, v44, s[14:15]
    v_cndmask_b32 v13, 0, v45, s[14:15]
    v_cndmask_b32 v14, 0, v44, s[16:17]
    v_cndmask_b32 v15, 0, v45, s[16:17]
    v_cndmask_b32 v16, 0, v44, s[18:19]
    v_cndmask_b32 v17, 0, v45, s[18:19]
    v_cndmask_b32 v18, 0, v44, s[20:21]
    v_cndmask_b32 v19, 0, v45, s[20:21]
    v_cndmask_b32 v20, 0, v44, s[22:23]
    v_cndmask_b32 v21, 0, v45, s[22:23]
    v_cndmask_b32 v22, 0, v44, s[24:25]
    v_cndmask_b32 v23, 0, v45, s[24:25]
    v_perm_b32 v84, v136, v128, s73
    v_perm_b32 v85, v152, v144, s73
    v_perm_b32 v86, v140, v132, s73
    v_perm_b32 v87, v156, v148, s73
    v_mfma_f32_16x16x16_bf16 v[76:79], v[8:9], v[84:85], v[76:79]
    v_perm_b32 v88, v136, v128, s74
    v_perm_b32 v89, v152, v144, s74
    v_mfma_f32_16x16x16_bf16 v[80:83], v[8:9], v[86:87], v[80:83]
    v_perm_b32 v90, v140, v132, s74
    v_perm_b32 v91, v156, v148, s74
    v_mfma_f32_16x16x16_bf16 v[76:79], v[10:11], v[88:89], v[76:79]
    v_perm_b32 v84, v137, v129, s73
    v_perm_b32 v85, v153, v145, s73
    v_mfma_f32_16x16x16_bf16 v[80:83], v[10:11], v[90:91], v[80:83]
    v_perm_b32 v86, v141, v133, s73
    v_perm_b32 v87, v157, v149, s73
    v_mfma_f32_16x16x16_bf16 v[76:79], v[12:13], v[84:85], v[76:79]
    v_perm_b32 v88, v137, v129, s74
    v_perm_b32 v89, v153, v145, s74
    v_mfma_f32_16x16x16_bf16 v[80:83], v[12:13], v[86:87], v[80:83]
    v_perm_b32 v90, v141, v133, s74
    v_perm_b32 v91, v157, v149, s74
    v_mfma_f32_16x16x16_bf16 v[76:79], v[14:15], v[88:89], v[76:79]
    v_perm_b32 v84, v138, v130, s73
    v_perm_b32 v85, v154, v146, s73
    v_mfma_f32_16x16x16_bf16 v[80:83], v[14:15], v[90:91], v[80:83]
    v_perm_b32 v86, v142, v134, s73
    v_perm_b32 v87, v158, v150, s73
    v_mfma_f32_16x16x16_bf16 v[76:79], v[16:17], v[84:85], v[76:79]
    v_perm_b32 v88, v138, v130, s74
    v_perm_b32 v89, v154, v146, s74
    v_mfma_f32_16x16x16_bf16 v[80:83], v[16:17], v[86:87], v[80:83]
    v_perm_b32 v90, v142, v134, s74
    v_perm_b32 v91, v158, v150, s74
    v_mfma_f32_16x16x16_bf16 v[76:79], v[18:19], v[88:89], v[76:79]
    v_perm_b32 v84, v139, v131, s73
    v_perm_b32 v85, v155, v147, s73
    v_mfma_f32_16x16x16_bf16 v[80:83], v[18:19], v[90:91], v[80:83]
    v_perm_b32 v86, v143, v135, s73
    v_perm_b32 v87, v159, v151, s73
    v_mfma_f32_16x16x16_bf16 v[76:79], v[20:21], v[84:85], v[76:79]
    v_perm_b32 v88, v139, v131, s74
    v_perm_b32 v89, v155, v147, s74
    v_mfma_f32_16x16x16_bf16 v[80:83], v[20:21], v[86:87], v[80:83]
    v_perm_b32 v90, v143, v135, s74
    v_perm_b32 v91, v159, v151, s74
    v_mfma_f32_16x16x16_bf16 v[76:79], v[22:23], v[88:89], v[76:79]
    s_nop 1
    v_mfma_f32_16x16x16_bf16 v[80:83], v[22:23], v[90:91], v[80:83]
    v_cndmask_b32 v8, 0, v48, s[10:11]
    v_cndmask_b32 v9, 0, v49, s[10:11]
    v_cndmask_b32 v10, 0, v48, s[12:13]
    v_cndmask_b32 v11, 0, v49, s[12:13]
    v_cndmask_b32 v12, 0, v48, s[14:15]
    v_cndmask_b32 v13, 0, v49, s[14:15]
    v_cndmask_b32 v14, 0, v48, s[16:17]
    v_cndmask_b32 v15, 0, v49, s[16:17]
    v_cndmask_b32 v16, 0, v48, s[18:19]
    v_cndmask_b32 v17, 0, v49, s[18:19]
    v_cndmask_b32 v18, 0, v48, s[20:21]
    v_cndmask_b32 v19, 0, v49, s[20:21]
    v_cndmask_b32 v20, 0, v48, s[22:23]
    v_cndmask_b32 v21, 0, v49, s[22:23]
    v_cndmask_b32 v22, 0, v48, s[24:25]
    v_cndmask_b32 v23, 0, v49, s[24:25]
    v_perm_b32 v84, v168, v160, s73
    v_perm_b32 v85, v184, v176, s73
    v_perm_b32 v86, v172, v164, s73
    v_perm_b32 v87, v188, v180, s73
    v_mfma_f32_16x16x16_bf16 v[76:79], v[8:9], v[84:85], v[76:79]
    v_perm_b32 v88, v168, v160, s74
    v_perm_b32 v89, v184, v176, s74
    v_mfma_f32_16x16x16_bf16 v[80:83], v[8:9], v[86:87], v[80:83]
    v_perm_b32 v90, v172, v164, s74
    v_perm_b32 v91, v188, v180, s74
    v_mfma_f32_16x16x16_bf16 v[76:79], v[10:11], v[88:89], v[76:79]
    v_perm_b32 v84, v169, v161, s73
    v_perm_b32 v85, v185, v177, s73
    v_mfma_f32_16x16x16_bf16 v[80:83], v[10:11], v[90:91], v[80:83]
    v_perm_b32 v86, v173, v165, s73
    v_perm_b32 v87, v189, v181, s73
    v_mfma_f32_16x16x16_bf16 v[76:79], v[12:13], v[84:85], v[76:79]
    v_perm_b32 v88, v169, v161, s74
    v_perm_b32 v89, v185, v177, s74
    v_mfma_f32_16x16x16_bf16 v[80:83], v[12:13], v[86:87], v[80:83]
    v_perm_b32 v90, v173, v165, s74
    v_perm_b32 v91, v189, v181, s74
    v_mfma_f32_16x16x16_bf16 v[76:79], v[14:15], v[88:89], v[76:79]
    v_perm_b32 v84, v170, v162, s73
    v_perm_b32 v85, v186, v178, s73
    v_mfma_f32_16x16x16_bf16 v[80:83], v[14:15], v[90:91], v[80:83]
    v_perm_b32 v86, v174, v166, s73
    v_perm_b32 v87, v190, v182, s73
    v_mfma_f32_16x16x16_bf16 v[76:79], v[16:17], v[84:85], v[76:79]
    v_perm_b32 v88, v170, v162, s74
    v_perm_b32 v89, v186, v178, s74
    v_mfma_f32_16x16x16_bf16 v[80:83], v[16:17], v[86:87], v[80:83]
    v_perm_b32 v90, v174, v166, s74
    v_perm_b32 v91, v190, v182, s74
    v_mfma_f32_16x16x16_bf16 v[76:79], v[18:19], v[88:89], v[76:79]
    v_perm_b32 v84, v171, v163, s73
    v_perm_b32 v85, v187, v179, s73
    v_mfma_f32_16x16x16_bf16 v[80:83], v[18:19], v[90:91], v[80:83]
    v_perm_b32 v86, v175, v167, s73
    v_perm_b32 v87, v191, v183, s73
    v_mfma_f32_16x16x16_bf16 v[76:79], v[20:21], v[84:85], v[76:79]
    v_perm_b32 v88, v171, v163, s74
    v_perm_b32 v89, v187, v179, s74
    v_mfma_f32_16x16x16_bf16 v[80:83], v[20:21], v[86:87], v[80:83]
    v_perm_b32 v90, v175, v167, s74
    v_perm_b32 v91, v191, v183, s74
    v_mfma_f32_16x16x16_bf16 v[76:79], v[22:23], v[88:89], v[76:79]
    s_nop 1
    v_mfma_f32_16x16x16_bf16 v[80:83], v[22:23], v[90:91], v[80:83]
    v_cndmask_b32 v8, 0, v52, s[10:11]
    v_cndmask_b32 v9, 0, v53, s[10:11]
    v_cndmask_b32 v10, 0, v52, s[12:13]
    v_cndmask_b32 v11, 0, v53, s[12:13]
    v_cndmask_b32 v12, 0, v52, s[14:15]
    v_cndmask_b32 v13, 0, v53, s[14:15]
    v_cndmask_b32 v14, 0, v52, s[16:17]
    v_cndmask_b32 v15, 0, v53, s[16:17]
    v_cndmask_b32 v16, 0, v52, s[18:19]
    v_cndmask_b32 v17, 0, v53, s[18:19]
    v_cndmask_b32 v18, 0, v52, s[20:21]
    v_cndmask_b32 v19, 0, v53, s[20:21]
    v_cndmask_b32 v20, 0, v52, s[22:23]
    v_cndmask_b32 v21, 0, v53, s[22:23]
    v_cndmask_b32 v22, 0, v52, s[24:25]
    v_cndmask_b32 v23, 0, v53, s[24:25]
    s_waitcnt vmcnt(7)
    s_bitcmp1_b32 m0, 12
    s_cbranch_scc1 L_sk76
    s_waitcnt vmcnt(2)
L_sk76:
    buffer_load_dwordx4 v[248:251], v1, s[36:39], s7 offen offset:1536 nt
    s_cmp_eq_u32 m0, -1
    s_cbranch_scc1 L_tg76
    s_cmp_lg_u32 s3, 0
    s_cbranch_scc1 L_to76
    s_waitcnt vmcnt(3)
    s_mov_b32 m0, -1
    v_mov_b32 v3, -1
    s_mov_b64 exec, 1
    ds_write_b32 v5, v3 offset:4116
    s_mov_b64 exec, -1
    s_branch L_tg76
L_to76:
L_tg76:
    s_waitcnt vmcnt(7)
    buffer_load_dwordx4 v[228:231], v1, s[36:39], s7 offen offset:256 nt
    s_waitcnt vmcnt(7)
    buffer_load_dwordx4 v[236:239], v1, s[36:39], s7 offen offset:768 nt
    s_waitcnt vmcnt(7)
    buffer_load_dwordx4 v[244:247], v1, s[36:39], s7 offen offset:1280 nt
    s_waitcnt vmcnt(7)
    buffer_load_dwordx4 v[252:255], v1, s[36:39], s7 offen offset:1792 nt
    v_perm_b32 v84, v200, v192, s73
    v_perm_b32 v85, v216, v208, s73
    v_perm_b32 v86, v204, v196, s73
    v_perm_b32 v87, v220, v212, s73
    v_mfma_f32_16x16x16_bf16 v[76:79], v[8:9], v[84:85], v[76:79]
    v_perm_b32 v88, v200, v192, s74
    v_perm_b32 v89, v216, v208, s74
    v_mfma_f32_16x16x16_bf16 v[80:83], v[8:9], v[86:87], v[80:83]
    v_perm_b32 v90, v204, v196, s74
    v_perm_b32 v91, v220, v212, s74
    v_mfma_f32_16x16x16_bf16 v[76:79], v[10:11], v[88:89], v[76:79]
    v_perm_b32 v84, v201, v193, s73
    v_perm_b32 v85, v217, v209, s73
    v_mfma_f32_16x16x16_bf16 v[80:83], v[10:11], v[90:91], v[80:83]
    v_perm_b32 v86, v205, v197, s73
    v_perm_b32 v87, v221, v213, s73
    v_mfma_f32_16x16x16_bf16 v[76:79], v[12:13], v[84:85], v[76:79]
    v_perm_b32 v88, v201, v193, s74
    v_perm_b32 v89, v217, v209, s74
    v_mfma_f32_16x16x16_bf16 v[80:83], v[12:13], v[86:87], v[80:83]
    v_perm_b32 v90, v205, v197, s74
    v_perm_b32 v91, v221, v213, s74
    v_mfma_f32_16x16x16_bf16 v[76:79], v[14:15], v[88:89], v[76:79]
    v_perm_b32 v84, v202, v194, s73
    v_perm_b32 v85, v218, v210, s73
    v_mfma_f32_16x16x16_bf16 v[80:83], v[14:15], v[90:91], v[80:83]
    v_perm_b32 v86, v206, v198, s73
    v_perm_b32 v87, v222, v214, s73
    v_mfma_f32_16x16x16_bf16 v[76:79], v[16:17], v[84:85], v[76:79]
    v_perm_b32 v88, v202, v194, s74
    v_perm_b32 v89, v218, v210, s74
    v_mfma_f32_16x16x16_bf16 v[80:83], v[16:17], v[86:87], v[80:83]
    v_perm_b32 v90, v206, v198, s74
    v_perm_b32 v91, v222, v214, s74
    v_mfma_f32_16x16x16_bf16 v[76:79], v[18:19], v[88:89], v[76:79]
    v_perm_b32 v84, v203, v195, s73
    v_perm_b32 v85, v219, v211, s73
    v_mfma_f32_16x16x16_bf16 v[80:83], v[18:19], v[90:91], v[80:83]
    v_perm_b32 v86, v207, v199, s73
    v_perm_b32 v87, v223, v215, s73
    v_mfma_f32_16x16x16_bf16 v[76:79], v[20:21], v[84:85], v[76:79]
    v_perm_b32 v88, v203, v195, s74
    v_perm_b32 v89, v219, v211, s74
    v_mfma_f32_16x16x16_bf16 v[80:83], v[20:21], v[86:87], v[80:83]
    v_perm_b32 v90, v207, v199, s74
    v_perm_b32 v91, v223, v215, s74
    v_mfma_f32_16x16x16_bf16 v[76:79], v[22:23], v[88:89], v[76:79]
    s_nop 1
    v_mfma_f32_16x16x16_bf16 v[80:83], v[22:23], v[90:91], v[80:83]
    v_cndmask_b32 v8, 0, v56, s[10:11]
    v_cndmask_b32 v9, 0, v57, s[10:11]
    v_cndmask_b32 v10, 0, v56, s[12:13]
    v_cndmask_b32 v11, 0, v57, s[12:13]
    v_cndmask_b32 v12, 0, v56, s[14:15]
    v_cndmask_b32 v13, 0, v57, s[14:15]
    v_cndmask_b32 v14, 0, v56, s[16:17]
    v_cndmask_b32 v15, 0, v57, s[16:17]
    v_cndmask_b32 v16, 0, v56, s[18:19]
    v_cndmask_b32 v17, 0, v57, s[18:19]
    v_cndmask_b32 v18, 0, v56, s[20:21]
    v_cndmask_b32 v19, 0, v57, s[20:21]
    v_cndmask_b32 v20, 0, v56, s[22:23]
    v_cndmask_b32 v21, 0, v57, s[22:23]
    v_cndmask_b32 v22, 0, v56, s[24:25]
    v_cndmask_b32 v23, 0, v57, s[24:25]
    s_waitcnt vmcnt(4)
    v_perm_b32 v84, v232, v224, s73
    v_perm_b32 v85, v248, v240, s73
    v_perm_b32 v86, v232, v224, s74
    v_perm_b32 v87, v248, v240, s74
    v_mfma_f32_16x16x16_bf16 v[76:79], v[8:9], v[84:85], v[76:79]
    v_perm_b32 v88, v233, v225, s73
    v_perm_b32 v89, v249, v241, s73
    v_mfma_f32_16x16x16_bf16 v[76:79], v[10:11], v[86:87], v[76:79]
    v_perm_b32 v90, v233, v225, s74
    v_perm_b32 v91, v249, v241, s74
    v_mfma_f32_16x16x16_bf16 v[76:79], v[12:13], v[88:89], v[76:79]
    v_perm_b32 v84, v234, v226, s73
    v_perm_b32 v85, v250, v242, s73
    v_mfma_f32_16x16x16_bf16 v[76:79], v[14:15], v[90:91], v[76:79]
    v_perm_b32 v86, v234, v226, s74
    v_perm_b32 v87, v250, v242, s74
    v_mfma_f32_16x16x16_bf16 v[76:79], v[16:17], v[84:85], v[76:79]
    v_perm_b32 v88, v235, v227, s73
    v_perm_b32 v89, v251, v243, s73
    v_mfma_f32_16x16x16_bf16 v[76:79], v[18:19], v[86:87], v[76:79]
    v_perm_b32 v90, v235, v227, s74
    v_perm_b32 v91, v251, v243, s74
    v_mfma_f32_16x16x16_bf16 v[76:79], v[20:21], v[88:89], v[76:79]
    s_nop 1
    v_mfma_f32_16x16x16_bf16 v[76:79], v[22:23], v[90:91], v[76:79]
    s_nop 7
    v_mul_f32 v76, s48, v76
    v_mul_f32 v77, s48, v77
    v_mul_f32 v78, s49, v78
    v_mul_f32 v79, s49, v79
    ds_write_b64 v2, v[76:77] offset:8192
    ds_write_b64 v2, v[78:79] offset:9216
    s_waitcnt vmcnt(0)
    v_perm_b32 v84, v236, v228, s73
    v_perm_b32 v85, v252, v244, s73
    v_perm_b32 v86, v236, v228, s74
    v_perm_b32 v87, v252, v244, s74
    v_mfma_f32_16x16x16_bf16 v[80:83], v[8:9], v[84:85], v[80:83]
    v_perm_b32 v88, v237, v229, s73
    v_perm_b32 v89, v253, v245, s73
    v_mfma_f32_16x16x16_bf16 v[80:83], v[10:11], v[86:87], v[80:83]
    v_perm_b32 v90, v237, v229, s74
    v_perm_b32 v91, v253, v245, s74
    v_mfma_f32_16x16x16_bf16 v[80:83], v[12:13], v[88:89], v[80:83]
    v_perm_b32 v84, v238, v230, s73
    v_perm_b32 v85, v254, v246, s73
    v_mfma_f32_16x16x16_bf16 v[80:83], v[14:15], v[90:91], v[80:83]
    v_perm_b32 v86, v238, v230, s74
    v_perm_b32 v87, v254, v246, s74
    v_mfma_f32_16x16x16_bf16 v[80:83], v[16:17], v[84:85], v[80:83]
    v_perm_b32 v88, v239, v231, s73
    v_perm_b32 v89, v255, v247, s73
    v_mfma_f32_16x16x16_bf16 v[80:83], v[18:19], v[86:87], v[80:83]
    v_perm_b32 v90, v239, v231, s74
    v_perm_b32 v91, v255, v247, s74
    v_mfma_f32_16x16x16_bf16 v[80:83], v[20:21], v[88:89], v[80:83]
    s_nop 1
    v_mfma_f32_16x16x16_bf16 v[80:83], v[22:23], v[90:91], v[80:83]
    s_nop 7
    v_mul_f32 v80, s48, v80
    v_mul_f32 v81, s48, v81
    v_mul_f32 v82, s49, v82
    v_mul_f32 v83, s49, v83
    ds_write_b64 v2, v[80:81] offset:8704
    ds_write_b64 v2, v[82:83] offset:9728
    buffer_load_dwordx2 v[24:25], v4, s[52:55], s30 offen offset:0 nt
    buffer_load_dwordx2 v[26:27], v4, s[52:55], s30 offen offset:896 nt
    buffer_load_dwordx2 v[28:29], v4, s[52:55], s30 offen offset:1792 nt
    buffer_load_dwordx2 v[30:31], v4, s[52:55], s30 offen offset:2688 nt
    buffer_load_dwordx2 v[32:33], v4, s[52:55], s31 offen offset:0 nt
    buffer_load_dwordx2 v[34:35], v4, s[52:55], s31 offen offset:896 nt
    buffer_load_dwordx2 v[36:37], v4, s[52:55], s31 offen offset:1792 nt
    buffer_load_dwordx2 v[38:39], v4, s[52:55], s31 offen offset:2688 nt
    s_waitcnt lgkmcnt(0)
    s_barrier
    s_cmp_ge_u32 s3, 4
    s_cbranch_scc1 L_not2
    buffer_load_dwordx4 v[188:191], v66, s[60:63], s29 offen sc1
    buffer_load_dwordx4 v[176:179], v63, s[60:63], s27 offen sc1
    s_waitcnt vmcnt(2)
    v_perm_b32 v128, v26, v24, s73
    v_perm_b32 v129, v30, v28, s73
    v_perm_b32 v130, v34, v32, s73
    v_perm_b32 v131, v38, v36, s73
    v_perm_b32 v132, v26, v24, s74
    v_perm_b32 v133, v30, v28, s74
    v_perm_b32 v134, v34, v32, s74
    v_perm_b32 v135, v38, v36, s74
    v_perm_b32 v136, v27, v25, s73
    v_perm_b32 v137, v31, v29, s73
    v_perm_b32 v138, v35, v33, s73
    v_perm_b32 v139, v39, v37, s73
    v_perm_b32 v140, v27, v25, s74
    v_perm_b32 v141, v31, v29, s74
    v_perm_b32 v142, v35, v33, s74
    v_perm_b32 v143, v39, v37, s74
    s_mov_b32 s78, 0
    s_waitcnt vmcnt(1)
L_stchk:
    v_cmp_ne_u32 vcc, s72, v190
    s_cbranch_vccnz L_stslow
    s_cmp_eq_u32 s70, 0
    s_cselect_b64 vcc, -1, 0
    v_cndmask_b32 v180, v189, v188, vcc
    s_nop 1
    v_max_f32_dpp v182, v180, v180 quad_perm:[1,0,3,2] row_mask:0xf bank_mask:0xf
    s_nop 1
    v_max_f32_dpp v182, v182, v182 quad_perm:[2,3,0,1] row_mask:0xf bank_mask:0xf
    s_nop 1
    v_max_f32_dpp v182, v182, v182 row_ror:4 row_mask:0xf bank_mask:0xf
    s_nop 1
    v_max_f32_dpp v182, v182, v182 row_ror:8 row_mask:0xf bank_mask:0xf
    v_sub_f32 v180, v180, v182
    v_exp_f32 v180, v180
    s_nop 1
    v_add_f32_dpp v182, v180, v180 quad_perm:[1,0,3,2] row_mask:0xf bank_mask:0xf
    s_nop 1
    v_add_f32_dpp v182, v182, v182 quad_perm:[2,3,0,1] row_mask:0xf bank_mask:0xf
    s_nop 1
    v_add_f32_dpp v182, v182, v182 row_ror:4 row_mask:0xf bank_mask:0xf
    s_nop 1
    v_add_f32_dpp v182, v182, v182 row_ror:8 row_mask:0xf bank_mask:0xf
    v_rcp_f32 v182, v182
    s_nop 0
    v_mul_f32 v180, v180, v182
L_h1poll:
    s_waitcnt vmcnt(0)
    v_xor_b32 v184, s56, v176
    v_xor_b32 v185, s57, v177
    v_xor_b32 v186, s58, v178
    v_xor_b32 v187, s59, v179
    v_or3_b32 v184, v184, v185, v186
    v_bitop3_b32 v184, v184, v187, v61 bitop3:0xa8
    v_cmp_ne_u32 vcc, 0, v184
    s_cbranch_vccz L_h1got
    s_mov_b64 exec, vcc
    buffer_load_dwordx4 v[176:179], v63, s[60:63], s27 offen sc1
    s_add_u32 s78, s78, 1
    s_cmp_lt_u32 s78, 400000
    s_cbranch_scc1 L_h1poll
    s_branch L_end
L_stslow:
    buffer_load_dwordx4 v[188:191], v66, s[60:63], s29 offen sc1
    s_waitcnt vmcnt(0)
    buffer_load_dwordx4 v[176:179], v63, s[60:63], s27 offen sc1
    s_add_u32 s78, s78, 1
    s_cmp_lt_u32 s78, 400000
    s_cbranch_scc1 L_stchk
    s_branch L_end
L_h1got:
    s_mov_b64 exec, -1
    v_mul_f32 v184, v176, v180
    v_mul_f32 v185, v177, v180
    v_mul_f32 v186, v178, v180
    v_mul_f32 v187, v179, v180
    v_add_f32_dpp v184, v184, v184 quad_perm:[1,0,3,2] row_mask:0xf bank_mask:0xf
    v_add_f32_dpp v185, v185, v185 quad_perm:[1,0,3,2] row_mask:0xf bank_mask:0xf
    v_add_f32_dpp v186, v186, v186 quad_perm:[1,0,3,2] row_mask:0xf bank_mask:0xf
    v_add_f32_dpp v187, v187, v187 quad_perm:[1,0,3,2] row_mask:0xf bank_mask:0xf
    v_add_f32_dpp v184, v184, v184 quad_perm:[2,3,0,1] row_mask:0xf bank_mask:0xf
    v_add_f32_dpp v185, v185, v185 quad_perm:[2,3,0,1] row_mask:0xf bank_mask:0xf
    v_add_f32_dpp v186, v186, v186 quad_perm:[2,3,0,1] row_mask:0xf bank_mask:0xf
    v_add_f32_dpp v187, v187, v187 quad_perm:[2,3,0,1] row_mask:0xf bank_mask:0xf
    v_add_f32_dpp v184, v184, v184 row_ror:4 row_mask:0xf bank_mask:0xf
    v_add_f32_dpp v185, v185, v185 row_ror:4 row_mask:0xf bank_mask:0xf
    v_add_f32_dpp v186, v186, v186 row_ror:4 row_mask:0xf bank_mask:0xf
    v_add_f32_dpp v187, v187, v187 row_ror:4 row_mask:0xf bank_mask:0xf
    v_add_f32_dpp v184, v184, v184 row_ror:8 row_mask:0xf bank_mask:0xf
    v_add_f32_dpp v185, v185, v185 row_ror:8 row_mask:0xf bank_mask:0xf
    v_add_f32_dpp v186, v186, v186 row_ror:8 row_mask:0xf bank_mask:0xf
    v_add_f32_dpp v187, v187, v187 row_ror:8 row_mask:0xf bank_mask:0xf
    v_cvt_pk_bf16_f32 v184, v184, v185
    v_cvt_pk_bf16_f32 v185, v186, v187
    ds_write_b64 v64, v[184:185] offset:4224
    s_waitcnt lgkmcnt(0)
L_t3:
    s_barrier
    ds_read_b128 v[144:147], v42
    ds_read_b128 v[148:151], v43
    ds_read_b128 v[152:155], v46
    ds_read_b128 v[156:159], v47
    s_waitcnt lgkmcnt(3)
    v_mfma_f32_16x16x32_bf16 v[160:163], v[144:147], v[128:131], 0
    s_waitcnt lgkmcnt(2)
    v_mfma_f32_16x16x32_bf16 v[160:163], v[148:151], v[132:135], v[160:163]
    s_waitcnt lgkmcnt(1)
    v_mfma_f32_16x16x32_bf16 v[160:163], v[152:155], v[136:139], v[160:163]
    s_waitcnt lgkmcnt(0)
    v_mfma_f32_16x16x32_bf16 v[160:163], v[156:159], v[140:143], v[160:163]
    s_mov_b32 exec_hi, 0
    s_nop 6
    v_bfi_b32 v160, v61, s56, v160
    v_bfi_b32 v161, v61, s57, v161
    v_bfi_b32 v162, v61, s58, v162
    v_bfi_b32 v163, v61, s59, v163
    buffer_store_dwordx4 v[160:163], v65, s[60:63], s28 offen sc1
    s_mov_b64 exec, -1
    s_branch L_done
L_not2:
    ds_read_b128 v[144:147], v60 offset:8192
    ds_read_b128 v[148:151], v60 offset:10240
    ds_read_b128 v[152:155], v60 offset:12288
    ds_read_b128 v[156:159], v60 offset:14336
    ds_read_b128 v[160:163], v60 offset:16384
    ds_read_b128 v[164:167], v60 offset:18432
    ds_read_b128 v[168:171], v60 offset:20480
    ds_read_b128 v[172:175], v60 offset:22528
    s_waitcnt lgkmcnt(6)
    v_pk_add_f32 v[144:145], v[144:145], v[148:149]
    v_pk_add_f32 v[146:147], v[146:147], v[150:151]
    s_waitcnt lgkmcnt(4)
    v_pk_add_f32 v[152:153], v[152:153], v[156:157]
    v_pk_add_f32 v[154:155], v[154:155], v[158:159]
    v_pk_add_f32 v[144:145], v[144:145], v[152:153]
    v_pk_add_f32 v[146:147], v[146:147], v[154:155]
    s_waitcnt lgkmcnt(2)
    v_pk_add_f32 v[160:161], v[160:161], v[164:165]
    v_pk_add_f32 v[162:163], v[162:163], v[166:167]
    s_waitcnt lgkmcnt(0)
    v_pk_add_f32 v[168:169], v[168:169], v[172:173]
    v_pk_add_f32 v[170:171], v[170:171], v[174:175]
    v_pk_add_f32 v[160:161], v[160:161], v[168:169]
    v_pk_add_f32 v[162:163], v[162:163], v[170:171]
    v_pk_add_f32 v[144:145], v[144:145], v[160:161]
    v_pk_add_f32 v[146:147], v[146:147], v[162:163]
    v_bfi_b32 v144, v61, s56, v144
    v_bfi_b32 v145, v61, s57, v145
    v_bfi_b32 v146, v61, s58, v146
    v_bfi_b32 v147, v61, s59, v147
    buffer_store_dwordx4 v[144:147], v62, s[60:63], s26 offen sc1
    s_mov_b64 exec, -1
    s_cmp_eq_u32 s3, 7
    s_cbranch_scc1 L_w7
    s_waitcnt vmcnt(1)
    v_perm_b32 v128, v26, v24, s73
    v_perm_b32 v129, v30, v28, s73
    v_perm_b32 v130, v34, v32, s73
    v_perm_b32 v131, v38, v36, s73
    v_perm_b32 v132, v26, v24, s74
    v_perm_b32 v133, v30, v28, s74
    v_perm_b32 v134, v34, v32, s74
    v_perm_b32 v135, v38, v36, s74
    v_perm_b32 v136, v27, v25, s73
    v_perm_b32 v137, v31, v29, s73
    v_perm_b32 v138, v35, v33, s73
    v_perm_b32 v139, v39, v37, s73
    v_perm_b32 v140, v27, v25, s74
    v_perm_b32 v141, v31, v29, s74
    v_perm_b32 v142, v35, v33, s74
    v_perm_b32 v143, v39, v37, s74
    s_branch L_t3
L_w7:
    s_cmp_lt_u32 s2, 112
    s_cbranch_scc1 L_final
    s_barrier
    s_branch L_done
L_qslow:
    s_mov_b32 s78, 0
L_qslow2:
    buffer_load_dwordx4 v[84:87], v5, s[60:63], s9 offen sc1
    s_waitcnt vmcnt(0)
    v_cmp_ne_u32 vcc, s72, v86
    s_cbranch_vccz L_qok
    s_add_u32 s78, s78, 1
    s_cmp_lt_u32 s78, 400000
    s_cbranch_scc1 L_qslow2
    s_branch L_end
L_final:
    s_mul_i32 s7, s2, 8192
    s_add_u32 s7, s7, 1245184
    s_add_u32 s8, s7, 4096
    buffer_load_dwordx4 v[192:195], v67, s[60:63], s7 offen offset:0 sc1
    buffer_load_dwordx4 v[196:199], v67, s[60:63], s7 offen offset:1024 sc1
    buffer_load_dwordx4 v[200:203], v67, s[60:63], s7 offen offset:2048 sc1
    buffer_load_dwordx4 v[204:207], v67, s[60:63], s7 offen offset:3072 sc1
    buffer_load_dwordx4 v[208:211], v67, s[60:63], s8 offen offset:0 sc1
    buffer_load_dwordx4 v[212:215], v67, s[60:63], s8 offen offset:1024 sc1
    buffer_load_dwordx4 v[216:219], v67, s[60:63], s8 offen offset:2048 sc1
    buffer_load_dwordx4 v[220:223], v67, s[60:63], s8 offen offset:3072 sc1
    s_mov_b32 s78, 0
    s_mul_i32 s10, s2, 16
    v_lshrrev_b32 v94, 1, v6
    v_mul_u32_u24 v94, 1792, v94
    v_lshl_add_u32 v94, v7, 2, v94
    v_and_b32 v95, 1, v6
    v_lshl_add_u32 v94, v95, 1, v94
    s_mov_b32 s12, 0xf000f
    s_mov_b32 s13, 0xf000f
    s_barrier
    buffer_load_dwordx4 v[192:195], v67, s[60:63], s7 offen offset:0 sc1
    buffer_load_dwordx4 v[196:199], v67, s[60:63], s7 offen offset:1024 sc1
    buffer_load_dwordx4 v[200:203], v67, s[60:63], s7 offen offset:2048 sc1
    buffer_load_dwordx4 v[204:207], v67, s[60:63], s7 offen offset:3072 sc1
    buffer_load_dwordx4 v[208:211], v67, s[60:63], s8 offen offset:0 sc1
    buffer_load_dwordx4 v[212:215], v67, s[60:63], s8 offen offset:1024 sc1
    buffer_load_dwordx4 v[216:219], v67, s[60:63], s8 offen offset:2048 sc1
    buffer_load_dwordx4 v[220:223], v67, s[60:63], s8 offen offset:3072 sc1
L_h2poll:
    s_waitcnt vmcnt(0)
    v_xor_b32 v184, s56, v192
    v_xor_b32 v185, s57, v193
    v_xor_b32 v186, s58, v194
    v_xor_b32 v187, s59, v195
    v_bitop3_b32 v184, v184, v196, s56 bitop3:0xf6
    v_bitop3_b32 v185, v185, v197, s57 bitop3:0xf6
    v_bitop3_b32 v186, v186, v198, s58 bitop3:0xf6
    v_bitop3_b32 v187, v187, v199, s59 bitop3:0xf6
    v_bitop3_b32 v184, v184, v200, s56 bitop3:0xf6
    v_bitop3_b32 v185, v185, v201, s57 bitop3:0xf6
    v_bitop3_b32 v186, v186, v202, s58 bitop3:0xf6
    v_bitop3_b32 v187, v187, v203, s59 bitop3:0xf6
    v_bitop3_b32 v184, v184, v204, s56 bitop3:0xf6
    v_bitop3_b32 v185, v185, v205, s57 bitop3:0xf6
    v_bitop3_b32 v186, v186, v206, s58 bitop3:0xf6
    v_bitop3_b32 v187, v187, v207, s59 bitop3:0xf6
    v_bitop3_b32 v184, v184, v208, s56 bitop3:0xf6
    v_bitop3_b32 v185, v185, v209, s57 bitop3:0xf6
    v_bitop3_b32 v186, v186, v210, s58 bitop3:0xf6
    v_bitop3_b32 v187, v187, v211, s59 bitop3:0xf6
    v_bitop3_b32 v184, v184, v212, s56 bitop3:0xf6
    v_bitop3_b32 v185, v185, v213, s57 bitop3:0xf6
    v_bitop3_b32 v186, v186, v214, s58 bitop3:0xf6
    v_bitop3_b32 v187, v187, v215, s59 bitop3:0xf6
    v_bitop3_b32 v184, v184, v216, s56 bitop3:0xf6
    v_bitop3_b32 v185, v185, v217, s57 bitop3:0xf6
    v_bitop3_b32 v186, v186, v218, s58 bitop3:0xf6
    v_bitop3_b32 v187, v187, v219, s59 bitop3:0xf6
    v_bitop3_b32 v184, v184, v220, s56 bitop3:0xf6
    v_bitop3_b32 v185, v185, v221, s57 bitop3:0xf6
    v_bitop3_b32 v186, v186, v222, s58 bitop3:0xf6
    v_bitop3_b32 v187, v187, v223, s59 bitop3:0xf6
    v_or3_b32 v184, v184, v185, v186
    v_bitop3_b32 v184, v184, v187, v61 bitop3:0xa8
    v_cmp_ne_u32 vcc, 0, v184
    s_cbranch_vccz L_h2got
    s_mov_b64 exec, vcc
    buffer_load_dwordx4 v[192:195], v67, s[60:63], s7 offen offset:0 sc1
    buffer_load_dwordx4 v[196:199], v67, s[60:63], s7 offen offset:1024 sc1
    buffer_load_dwordx4 v[200:203], v67, s[60:63], s7 offen offset:2048 sc1
    buffer_load_dwordx4 v[204:207], v67, s[60:63], s7 offen offset:3072 sc1
    buffer_load_dwordx4 v[208:211], v67, s[60:63], s8 offen offset:0 sc1
    buffer_load_dwordx4 v[212:215], v67, s[60:63], s8 offen offset:1024 sc1
    buffer_load_dwordx4 v[216:219], v67, s[60:63], s8 offen offset:2048 sc1
    buffer_load_dwordx4 v[220:223], v67, s[60:63], s8 offen offset:3072 sc1
    s_add_u32 s78, s78, 1
    s_cmp_lt_u32 s78, 400000
    s_cbranch_scc1 L_h2poll
    s_branch L_end
L_h2got:
    s_mov_b64 exec, -1
    v_pk_add_f32 v[128:129], v[192:193], v[208:209]
    v_pk_add_f32 v[130:131], v[194:195], v[210:211]
    v_pk_add_f32 v[132:133], v[196:197], v[212:213]
    v_pk_add_f32 v[134:135], v[198:199], v[214:215]
    v_pk_add_f32 v[136:137], v[200:201], v[216:217]
    v_pk_add_f32 v[138:139], v[202:203], v[218:219]
    v_pk_add_f32 v[140:141], v[204:205], v[220:221]
    v_pk_add_f32 v[142:143], v[206:207], v[222:223]
    v_pk_add_f32 v[128:129], v[128:129], v[136:137]
    v_pk_add_f32 v[130:131], v[130:131], v[138:139]
    v_pk_add_f32 v[132:133], v[132:133], v[140:141]
    v_pk_add_f32 v[134:135], v[134:135], v[142:143]
    v_pk_add_f32 v[128:129], v[128:129], v[132:133]
    v_pk_add_f32 v[130:131], v[130:131], v[134:135]
    s_nop 1
    v_permlane32_swap_b32 v128, v129
    v_permlane32_swap_b32 v130, v131
    s_nop 1
    v_add_f32 v128, v128, v129
    v_add_f32 v130, v130, v131
    s_nop 1
    v_permlane16_swap_b32 v128, v130
    s_nop 1
    v_add_f32 v128, v128, v130
    s_nop 1
    v_add_f32_dpp v128, v128, v128 row_ror:4 row_mask:0xf bank_mask:0xf
    s_nop 1
    v_add_f32_dpp v128, v128, v128 row_ror:8 row_mask:0xf bank_mask:0xf
    s_mov_b64 exec, s[12:13]
    v_cvt_pk_bf16_f32 v128, v128, v128
    buffer_store_short v128, v94, s[64:67], s10 offen
    s_cmp_lg_u32 s2, 0
    s_cbranch_scc1 L_noepoch
    s_mov_b64 exec, 1
    v_mov_b32 v129, s72
    v_mov_b32 v94, 0
    buffer_store_dword v129, v94, s[60:63], 0 offen
L_noepoch:
    s_mov_b64 exec, -1
L_done:
L_end:
    s_waitcnt vmcnt(0)
    s_endpgm
.section .rodata,"a"
.p2align 6
.amdhsa_kernel concat_heads__gqa_block_cached__sliding_block_cached__decode_kernel
  .amdhsa_next_free_vgpr 256
  .amdhsa_next_free_sgpr 102
  .amdhsa_accum_offset 256
  .amdhsa_group_segment_fixed_size 0
  .amdhsa_kernarg_size 104
  .amdhsa_user_sgpr_count 2
  .amdhsa_user_sgpr_kernarg_segment_ptr 1
  .amdhsa_system_sgpr_workgroup_id_x 1
.end_amdhsa_kernel
```
